```python
import torch

def _softmax(x, axis=-1):
    return torch.softmax(x, dim=axis)
def _gelu(x):
    return torch.nn.functional.gelu(x, approximate="tanh")
def _silu(x):
    return torch.nn.functional.silu(x)
def _sigmoid(x):
    return torch.sigmoid(x)
def _layernorm(x, axis=-1, eps=1e-5):
    m = x.mean(dim=axis, keepdim=True)
    v = x.var(dim=axis, keepdim=True, unbiased=False)
    return (x - m) / torch.sqrt(v + eps)
def _scatter_add(tgt, idx, src, axis=0):
    return tgt.clone().index_add_(axis, idx, src)
def _segment_sum(src, seg, n):
    out = torch.zeros((n,) + src.shape[1:], dtype=src.dtype)
    return out.index_add_(0, seg, src)
def _pad(x, pw):
    flat = tuple(v for pair in reversed(pw) for v in pair)
    return torch.nn.functional.pad(x, flat)

kernel_name = 'parallel_sum__linear_kernel_hedgehog__glu_gated_reglu__prompt'

def setup_inputs():

    _w = (lambda a: (lambda t: t.to(torch.bfloat16) if t.is_floating_point() else t)(torch.as_tensor(a)))
    def _A_setup():
        B, S, D, H = 1, 2048, 1024, 32
        Dh = D // H
        return {
            "x": _w((lambda *s: torch.randn(*s, dtype=torch.bfloat16) * 0.05)(B, S, D)),
            "wqkv": _w((lambda *s: torch.randn(*s, dtype=torch.bfloat16) * 0.2)(D, 3 * D)),
            "w_phi": _w((lambda *s: torch.randn(*s, dtype=torch.bfloat16) * 0.2)(H, Dh, Dh) * (Dh ** -0.5)),
            "wo": _w((lambda *s: torch.randn(*s, dtype=torch.bfloat16) * 0.05)(D, D)),
        }
    _A_in = _A_setup()

    def _B_setup():
        B, S, D, F = 1, 2048, 1024, 3584
        return {
            "x": _w((lambda *s: torch.randn(*s, dtype=torch.bfloat16) * 0.05)(B, S, D)),
            "W_gate": _w((lambda *s: torch.randn(*s, dtype=torch.bfloat16) * 0.4)(D, F) * (2.0 / D) ** 0.5),
            "W_up": _w((lambda *s: torch.randn(*s, dtype=torch.bfloat16) * 0.4)(D, F) * (2.0 / D) ** 0.5),
            "W_down": _w((lambda *s: torch.randn(*s, dtype=torch.bfloat16) * 0.4)(F, D) * (1.0 / F) ** 0.5),
        }
    _B_in = _B_setup()

    return {
        "A_x": _A_in["x"],
        "A_wqkv": _A_in["wqkv"],
        "A_w_phi": _A_in["w_phi"],
        "A_wo": _A_in["wo"],
        "B_x": _B_in["x"],
        "B_W_gate": _B_in["W_gate"],
        "B_W_up": _B_in["W_up"],
        "B_W_down": _B_in["W_down"],
    }

def reference(A_x, A_wqkv, A_w_phi, A_wo, B_x, B_W_gate, B_W_up, B_W_down):
    def _A_ref(x, wqkv, w_phi, wo):
        B, S, D = x.shape
        H = 32; Dh = D // H
        qkv = (lambda x, *d: x.permute(*d))((x @ wqkv).reshape(B, S, 3, H, Dh), 2, 0, 3, 1, 4)
        q, k, v = qkv[0], qkv[1], qkv[2]
        pq = torch.einsum("bhsd,hdf->bhsf", q, w_phi)
        pk = torch.einsum("bhsd,hdf->bhsf", k, w_phi)
        phi_q = torch.concatenate([_softmax(pq, axis=-1), _softmax(-pq, axis=-1)], axis=-1)
        phi_k = torch.concatenate([_softmax(pk, axis=-1), _softmax(-pk, axis=-1)], axis=-1)
        kv = torch.einsum("bhsf,bhsd->bhfd", phi_k, v)
        z  = torch.einsum("bhsf->bhf", phi_k)
        num = torch.einsum("bhqf,bhfd->bhqd", phi_q, kv)
        den = torch.einsum("bhqf,bhf->bhq", phi_q, z)[..., None] + 1e-6
        o = num / den
        return (lambda x, *d: x.permute(*d))(o, 0, 2, 1, 3).reshape(B, S, D) @ wo

    def _B_ref(x, W_gate, W_up, W_down):
        gate = torch.einsum("bsd,df->bsf", x, W_gate)
        up = torch.einsum("bsd,df->bsf", x, W_up)
        gate = gate * (lambda x, dt: x.to(dt))(gate > 0, gate.dtype)
        h = gate * up
        return torch.einsum("bsf,fd->bsd", h, W_down)

    x = A_x
    xn = _layernorm(x, axis=-1)
    return x + _A_ref(xn, A_wqkv, A_w_phi, A_wo) + _B_ref(xn, B_W_gate, B_W_up, B_W_down)
```

```asm
; @launch kernel=k2_gemm1_kernel grid=(256,1,1) block=(256,1,1) lds=106496
; @launch kernel=k3_gemm2_kernel grid=(512,1,1) block=(256,1,1) lds=73728
.amdgcn_target "amdgcn-amd-amdhsa--gfx950"
.text
.globl k2_gemm1_kernel
.p2align 8
.type k2_gemm1_kernel,@function
k2_gemm1_kernel:
  s_cmp_ge_u32 s2, 256
  s_cbranch_scc1 L_k2_end
  s_load_dwordx2 s[4:5], s[0:1], 8
  s_load_dwordx2 s[6:7], s[0:1], 40
  s_load_dwordx2 s[60:61], s[0:1], 48
  s_load_dwordx2 s[62:63], s[0:1], 80
  s_load_dwordx2 s[64:65], s[0:1], 16
  s_load_dwordx2 s[56:57], s[0:1], 0
  s_load_dwordx2 s[76:77], s[0:1], 72
  v_lshrrev_b32 v10, 6, v0
  v_and_b32 v0, 63, v0
  s_and_b32 s51, s2, 7
  v_readfirstlane_b32 s47, v10
  s_lshr_b32 s52, s2, 3
  s_and_b32 s53, s52, 3
  s_lshl_b32 s48, s51, 2
  s_add_u32 s48, s48, s53
  s_lshr_b32 s49, s52, 2
  v_lshlrev_b32 v1, 4, v0
  s_waitcnt lgkmcnt(0)
  s_mov_b32 s58, 4194304
  s_mov_b32 s59, 0x00020000
  v_and_b32 v10, 7, v0
  v_lshlrev_b32 v10, 11, v10
  v_lshrrev_b32 v11, 3, v0
  v_lshl_add_u32 v10, v11, 4, v10
  s_lshl_b32 s51, s47, 9
  v_add_u32 v10, s51, v10
  s_lshl_b32 s51, s49, 8
  s_lshl_b32 s52, s48, 3
  s_add_u32 s51, s51, s52
  s_lshl_b32 s51, s51, 11
  buffer_load_dwordx4 v[16:19], v10, s[56:59], s51 offen offset:0
  buffer_load_dwordx4 v[20:23], v10, s[56:59], s51 offen offset:128
  buffer_load_dwordx4 v[24:27], v10, s[56:59], s51 offen offset:256
  buffer_load_dwordx4 v[28:31], v10, s[56:59], s51 offen offset:384
  s_mov_b32 s78, 256
  s_mov_b32 s79, 0x00020000
  v_mov_b32 v13, 252
  s_or_b32 s51, s2, s47
  s_cmp_eq_u32 s51, 0
  s_cbranch_scc0 L_k2_nonce0
  s_memrealtime s[86:87]
  s_waitcnt lgkmcnt(0)
  s_or_b32 s86, s86, 1
  v_mov_b32 v14, s86
  s_mov_b64 exec, 1
  buffer_store_dword v14, v13, s[76:79], 0 offen sc1
  s_mov_b64 exec, -1
L_k2_nonce0:
  s_getpc_b64 s[84:85]
L_k2_pc:
  s_sub_u32 s84, s84, L_k2_pc-k2_gemm1_kernel
  s_subb_u32 s85, s85, 0
  s_lshr_b32 s51, s2, 3
  s_lshl_b32 s51, s51, 10
  v_and_b32 v12, 7, v0
  v_lshlrev_b32 v12, 7, v12
  v_add_u32 v12, s51, v12
  v_min_u32 v12, L_code_end-k2_gemm1_kernel-4, v12
  global_load_dword a247, v12, s[84:85]
  s_lshl_b32 s51, s49, 2
  s_add_u32 s51, s51, s47
  s_lshl_b32 s51, s51, 17
  s_add_u32 s8, s62, s51
  s_addc_u32 s9, s63, 0
  s_mov_b32 s10, 131072
  s_mov_b32 s11, 0x00020000
  s_and_b32 s51, s48, 3
  s_lshl_b32 s51, s51, 1
  s_add_u32 s51, s51, s49
  s_and_b32 s72, s51, 7
  s_mov_b32 s70, s72
  s_mov_b32 s71, 0
  s_mov_b32 s73, s72
  s_mov_b32 s68, 7340032
  s_mov_b32 s69, 229376
  s_mov_b32 s66, 4294885376
  s_mov_b32 s67, 20480
  s_mul_i32 s54, s47, 5
  s_mul_i32 s55, s48, 224
  s_lshl_b32 s56, s48, 6
  s_lshl_b32 s43, s54, 10
  s_add_u32 s44, s43, 81920
  s_mov_b32 s45, 0
  s_add_u32 s51, s54, 0
  s_cmp_lt_u32 s51, 13
  s_cselect_b32 s12, s6, s60
  s_cselect_b32 s13, s7, s61
  s_cselect_b32 s52, 6, 13
  s_cmp_lt_u32 s51, 6
  s_cselect_b32 s12, s4, s12
  s_cselect_b32 s13, s5, s13
  s_cselect_b32 s14, 6291456, s68
  s_mov_b32 s15, 0x00020000
  s_cselect_b32 s52, 0, s52
  s_cselect_b32 s37, 196608, s69
  s_sub_u32 s53, s51, s52
  s_lshl_b32 s53, s53, 6
  v_add_u32 v10, s53, v0
  s_cmp_lt_u32 s51, 6
  s_cbranch_scc1 L_k2_q0
  v_mul_u32_u24 v11, 4682, v10
  v_lshrrev_b32 v11, 16, v11
  v_mul_u32_u24 v12, 14, v11
  v_sub_u32 v12, v10, v12
  v_mul_u32_u24 v11, 7168, v11
  v_lshl_add_u32 v11, v12, 4, v11
  v_add_u32 v2, s55, v11
  s_branch L_k2_qd0
L_k2_q0:
  v_mul_u32_u24 v12, 5462, v10
  v_lshrrev_b32 v12, 16, v12
  v_mul_u32_u24 v13, 12, v12
  v_sub_u32 v13, v10, v13
  v_lshrrev_b32 v14, 2, v13
  v_and_b32 v13, 3, v13
  v_lshrrev_b32 v15, 1, v12
  v_and_b32 v15, 2, v15
  v_xor_b32 v13, v13, v15
  v_mul_u32_u24 v12, 6144, v12
  v_lshl_add_u32 v12, v14, 11, v12
  v_lshl_add_u32 v12, v13, 4, v12
  v_add_u32 v2, s56, v12
L_k2_qd0:
  s_add_u32 m0, s43, 0
  s_mul_i32 s32, s73, s37
  buffer_load_dwordx4 v2, s[12:15], s32 offen lds
  s_add_u32 s51, s54, 1
  s_cmp_lt_u32 s51, 13
  s_cselect_b32 s16, s6, s60
  s_cselect_b32 s17, s7, s61
  s_cselect_b32 s52, 6, 13
  s_cmp_lt_u32 s51, 6
  s_cselect_b32 s16, s4, s16
  s_cselect_b32 s17, s5, s17
  s_cselect_b32 s18, 6291456, s68
  s_mov_b32 s19, 0x00020000
  s_cselect_b32 s52, 0, s52
  s_cselect_b32 s38, 196608, s69
  s_sub_u32 s53, s51, s52
  s_lshl_b32 s53, s53, 6
  v_add_u32 v10, s53, v0
  s_cmp_lt_u32 s51, 6
  s_cbranch_scc1 L_k2_q1
  v_mul_u32_u24 v11, 4682, v10
  v_lshrrev_b32 v11, 16, v11
  v_mul_u32_u24 v12, 14, v11
  v_sub_u32 v12, v10, v12
  v_mul_u32_u24 v11, 7168, v11
  v_lshl_add_u32 v11, v12, 4, v11
  v_add_u32 v3, s55, v11
  s_branch L_k2_qd1
L_k2_q1:
  v_mul_u32_u24 v12, 5462, v10
  v_lshrrev_b32 v12, 16, v12
  v_mul_u32_u24 v13, 12, v12
  v_sub_u32 v13, v10, v13
  v_lshrrev_b32 v14, 2, v13
  v_and_b32 v13, 3, v13
  v_lshrrev_b32 v15, 1, v12
  v_and_b32 v15, 2, v15
  v_xor_b32 v13, v13, v15
  v_mul_u32_u24 v12, 6144, v12
  v_lshl_add_u32 v12, v14, 11, v12
  v_lshl_add_u32 v12, v13, 4, v12
  v_add_u32 v3, s56, v12
L_k2_qd1:
  s_add_u32 m0, s43, 1024
  s_mul_i32 s33, s73, s38
  buffer_load_dwordx4 v3, s[16:19], s33 offen lds
  s_add_u32 s51, s54, 2
  s_cmp_lt_u32 s51, 13
  s_cselect_b32 s20, s6, s60
  s_cselect_b32 s21, s7, s61
  s_cselect_b32 s52, 6, 13
  s_cmp_lt_u32 s51, 6
  s_cselect_b32 s20, s4, s20
  s_cselect_b32 s21, s5, s21
  s_cselect_b32 s22, 6291456, s68
  s_mov_b32 s23, 0x00020000
  s_cselect_b32 s52, 0, s52
  s_cselect_b32 s39, 196608, s69
  s_sub_u32 s53, s51, s52
  s_lshl_b32 s53, s53, 6
  v_add_u32 v10, s53, v0
  s_cmp_lt_u32 s51, 6
  s_cbranch_scc1 L_k2_q2
  v_mul_u32_u24 v11, 4682, v10
  v_lshrrev_b32 v11, 16, v11
  v_mul_u32_u24 v12, 14, v11
  v_sub_u32 v12, v10, v12
  v_mul_u32_u24 v11, 7168, v11
  v_lshl_add_u32 v11, v12, 4, v11
  v_add_u32 v4, s55, v11
  s_branch L_k2_qd2
L_k2_q2:
  v_mul_u32_u24 v12, 5462, v10
  v_lshrrev_b32 v12, 16, v12
  v_mul_u32_u24 v13, 12, v12
  v_sub_u32 v13, v10, v13
  v_lshrrev_b32 v14, 2, v13
  v_and_b32 v13, 3, v13
  v_lshrrev_b32 v15, 1, v12
  v_and_b32 v15, 2, v15
  v_xor_b32 v13, v13, v15
  v_mul_u32_u24 v12, 6144, v12
  v_lshl_add_u32 v12, v14, 11, v12
  v_lshl_add_u32 v12, v13, 4, v12
  v_add_u32 v4, s56, v12
L_k2_qd2:
  s_add_u32 m0, s43, 2048
  s_mul_i32 s34, s73, s39
  buffer_load_dwordx4 v4, s[20:23], s34 offen lds
  s_add_u32 s51, s54, 3
  s_cmp_lt_u32 s51, 13
  s_cselect_b32 s24, s6, s60
  s_cselect_b32 s25, s7, s61
  s_cselect_b32 s52, 6, 13
  s_cmp_lt_u32 s51, 6
  s_cselect_b32 s24, s4, s24
  s_cselect_b32 s25, s5, s25
  s_cselect_b32 s26, 6291456, s68
  s_mov_b32 s27, 0x00020000
  s_cselect_b32 s52, 0, s52
  s_cselect_b32 s40, 196608, s69
  s_sub_u32 s53, s51, s52
  s_lshl_b32 s53, s53, 6
  v_add_u32 v10, s53, v0
  s_cmp_lt_u32 s51, 6
  s_cbranch_scc1 L_k2_q3
  v_mul_u32_u24 v11, 4682, v10
  v_lshrrev_b32 v11, 16, v11
  v_mul_u32_u24 v12, 14, v11
  v_sub_u32 v12, v10, v12
  v_mul_u32_u24 v11, 7168, v11
  v_lshl_add_u32 v11, v12, 4, v11
  v_add_u32 v5, s55, v11
  s_branch L_k2_qd3
L_k2_q3:
  v_mul_u32_u24 v12, 5462, v10
  v_lshrrev_b32 v12, 16, v12
  v_mul_u32_u24 v13, 12, v12
  v_sub_u32 v13, v10, v13
  v_lshrrev_b32 v14, 2, v13
  v_and_b32 v13, 3, v13
  v_lshrrev_b32 v15, 1, v12
  v_and_b32 v15, 2, v15
  v_xor_b32 v13, v13, v15
  v_mul_u32_u24 v12, 6144, v12
  v_lshl_add_u32 v12, v14, 11, v12
  v_lshl_add_u32 v12, v13, 4, v12
  v_add_u32 v5, s56, v12
L_k2_qd3:
  s_add_u32 m0, s43, 3072
  s_mul_i32 s35, s73, s40
  buffer_load_dwordx4 v5, s[24:27], s35 offen lds
  s_add_u32 s51, s54, 4
  s_cmp_lt_u32 s51, 13
  s_cselect_b32 s28, s6, s60
  s_cselect_b32 s29, s7, s61
  s_cselect_b32 s52, 6, 13
  s_cmp_lt_u32 s51, 6
  s_cselect_b32 s28, s4, s28
  s_cselect_b32 s29, s5, s29
  s_cselect_b32 s30, 6291456, s68
  s_mov_b32 s31, 0x00020000
  s_cselect_b32 s52, 0, s52
  s_cselect_b32 s41, 196608, s69
  s_sub_u32 s53, s51, s52
  s_lshl_b32 s53, s53, 6
  v_add_u32 v10, s53, v0
  s_cmp_lt_u32 s51, 6
  s_cbranch_scc1 L_k2_q4
  v_mul_u32_u24 v11, 4682, v10
  v_lshrrev_b32 v11, 16, v11
  v_mul_u32_u24 v12, 14, v11
  v_sub_u32 v12, v10, v12
  v_mul_u32_u24 v11, 7168, v11
  v_lshl_add_u32 v11, v12, 4, v11
  v_add_u32 v6, s55, v11
  s_branch L_k2_qd4
L_k2_q4:
  v_mul_u32_u24 v12, 5462, v10
  v_lshrrev_b32 v12, 16, v12
  v_mul_u32_u24 v13, 12, v12
  v_sub_u32 v13, v10, v13
  v_lshrrev_b32 v14, 2, v13
  v_and_b32 v13, 3, v13
  v_lshrrev_b32 v15, 1, v12
  v_and_b32 v15, 2, v15
  v_xor_b32 v13, v13, v15
  v_mul_u32_u24 v12, 6144, v12
  v_lshl_add_u32 v12, v14, 11, v12
  v_lshl_add_u32 v12, v13, 4, v12
  v_add_u32 v6, s56, v12
L_k2_qd4:
  s_add_u32 m0, s43, 4096
  s_mul_i32 s36, s73, s41
  buffer_load_dwordx4 v6, s[28:31], s36 offen lds
  s_lshl_b32 s42, s73, 12
  s_add_u32 s70, s70, 1
  s_and_b32 s70, s70, 7
  s_cmp_eq_u32 s70, s72
  s_cselect_b32 s51, 8, 0
  s_add_u32 s71, s71, s51
  s_add_u32 s73, s71, s70
  s_cmp_eq_u32 s43, s44
  s_cselect_b32 s51, s66, s67
  s_add_u32 s43, s43, s51
  s_mov_b32 s95, s42
  s_waitcnt vmcnt(6)
  s_mov_b32 s51, 0xffff0000
  v_lshlrev_b32 v32, 16, v16
  v_and_b32 v33, s51, v16
  v_lshlrev_b32 v34, 16, v17
  v_and_b32 v35, s51, v17
  v_lshlrev_b32 v36, 16, v18
  v_and_b32 v37, s51, v18
  v_lshlrev_b32 v38, 16, v19
  v_and_b32 v39, s51, v19
  v_lshlrev_b32 v40, 16, v20
  v_and_b32 v41, s51, v20
  v_lshlrev_b32 v42, 16, v21
  v_and_b32 v43, s51, v21
  v_lshlrev_b32 v44, 16, v22
  v_and_b32 v45, s51, v22
  v_lshlrev_b32 v46, 16, v23
  v_and_b32 v47, s51, v23
  v_lshlrev_b32 v48, 16, v24
  v_and_b32 v49, s51, v24
  v_lshlrev_b32 v50, 16, v25
  v_and_b32 v51, s51, v25
  v_lshlrev_b32 v52, 16, v26
  v_and_b32 v53, s51, v26
  v_lshlrev_b32 v54, 16, v27
  v_and_b32 v55, s51, v27
  v_lshlrev_b32 v56, 16, v28
  v_and_b32 v57, s51, v28
  v_lshlrev_b32 v58, 16, v29
  v_and_b32 v59, s51, v29
  v_lshlrev_b32 v60, 16, v30
  v_and_b32 v61, s51, v30
  v_lshlrev_b32 v62, 16, v31
  v_and_b32 v63, s51, v31
  v_pk_add_f32 v[64:65], v[32:33], v[34:35]
  v_pk_add_f32 v[66:67], v[36:37], v[38:39]
  v_pk_add_f32 v[64:65], v[64:65], v[40:41]
  v_pk_add_f32 v[66:67], v[66:67], v[42:43]
  v_pk_add_f32 v[64:65], v[64:65], v[44:45]
  v_pk_add_f32 v[66:67], v[66:67], v[46:47]
  v_pk_add_f32 v[64:65], v[64:65], v[48:49]
  v_pk_add_f32 v[66:67], v[66:67], v[50:51]
  v_pk_add_f32 v[64:65], v[64:65], v[52:53]
  v_pk_add_f32 v[66:67], v[66:67], v[54:55]
  v_pk_add_f32 v[64:65], v[64:65], v[56:57]
  v_pk_add_f32 v[66:67], v[66:67], v[58:59]
  v_pk_add_f32 v[64:65], v[64:65], v[60:61]
  v_pk_add_f32 v[66:67], v[66:67], v[62:63]
  v_and_b32 v68, 7, v0
  v_lshlrev_b32 v68, 4, v68
  v_add_u32 v68, 104448, v68
  s_lshl_b32 s52, s47, 2
  v_add_u32 v69, s52, v68
  v_pk_add_f32 v[64:65], v[64:65], v[66:67]
  v_add_f32 v64, v64, v65
  s_nop 1
  v_add_f32_dpp v64, v64, v64 row_ror:8 row_mask:0xf bank_mask:0xf
  v_mov_b32 v65, v64
  s_nop 1
  v_permlane16_swap_b32 v64, v65
  s_nop 0
  v_add_f32 v64, v64, v65
  v_mov_b32 v65, v64
  s_nop 1
  v_permlane32_swap_b32 v64, v65
  s_nop 0
  v_add_f32 v64, v64, v65
  ds_write_b32 v69, v64 offset:0
  s_waitcnt lgkmcnt(0)
  s_barrier
  ds_read_b128 v[64:67], v68 offset:0
  s_waitcnt lgkmcnt(0)
  v_pk_add_f32 v[64:65], v[64:65], v[66:67]
  v_add_f32 v64, v64, v65
  v_mul_f32 v64, 0xba800000, v64
  v_pk_add_f32 v[32:33], v[32:33], v[64:65] op_sel_hi:[1,0]
  v_pk_add_f32 v[34:35], v[34:35], v[64:65] op_sel_hi:[1,0]
  v_pk_add_f32 v[36:37], v[36:37], v[64:65] op_sel_hi:[1,0]
  v_pk_add_f32 v[38:39], v[38:39], v[64:65] op_sel_hi:[1,0]
  v_pk_add_f32 v[40:41], v[40:41], v[64:65] op_sel_hi:[1,0]
  v_pk_add_f32 v[42:43], v[42:43], v[64:65] op_sel_hi:[1,0]
  v_pk_add_f32 v[44:45], v[44:45], v[64:65] op_sel_hi:[1,0]
  v_pk_add_f32 v[46:47], v[46:47], v[64:65] op_sel_hi:[1,0]
  v_pk_add_f32 v[48:49], v[48:49], v[64:65] op_sel_hi:[1,0]
  v_pk_add_f32 v[50:51], v[50:51], v[64:65] op_sel_hi:[1,0]
  v_pk_add_f32 v[52:53], v[52:53], v[64:65] op_sel_hi:[1,0]
  v_pk_add_f32 v[54:55], v[54:55], v[64:65] op_sel_hi:[1,0]
  v_pk_add_f32 v[56:57], v[56:57], v[64:65] op_sel_hi:[1,0]
  v_pk_add_f32 v[58:59], v[58:59], v[64:65] op_sel_hi:[1,0]
  v_pk_add_f32 v[60:61], v[60:61], v[64:65] op_sel_hi:[1,0]
  v_pk_add_f32 v[62:63], v[62:63], v[64:65] op_sel_hi:[1,0]
  v_pk_mul_f32 v[64:65], v[32:33], v[32:33]
  v_pk_mul_f32 v[66:67], v[34:35], v[34:35]
  v_pk_fma_f32 v[64:65], v[36:37], v[36:37], v[64:65]
  v_pk_fma_f32 v[66:67], v[38:39], v[38:39], v[66:67]
  v_pk_fma_f32 v[64:65], v[40:41], v[40:41], v[64:65]
  v_pk_fma_f32 v[66:67], v[42:43], v[42:43], v[66:67]
  v_pk_fma_f32 v[64:65], v[44:45], v[44:45], v[64:65]
  v_pk_fma_f32 v[66:67], v[46:47], v[46:47], v[66:67]
  v_pk_fma_f32 v[64:65], v[48:49], v[48:49], v[64:65]
  v_pk_fma_f32 v[66:67], v[50:51], v[50:51], v[66:67]
  v_pk_fma_f32 v[64:65], v[52:53], v[52:53], v[64:65]
  v_pk_fma_f32 v[66:67], v[54:55], v[54:55], v[66:67]
  v_pk_fma_f32 v[64:65], v[56:57], v[56:57], v[64:65]
  v_pk_fma_f32 v[66:67], v[58:59], v[58:59], v[66:67]
  v_pk_fma_f32 v[64:65], v[60:61], v[60:61], v[64:65]
  v_pk_fma_f32 v[66:67], v[62:63], v[62:63], v[66:67]
  v_pk_add_f32 v[64:65], v[64:65], v[66:67]
  v_add_f32 v64, v64, v65
  s_nop 1
  v_add_f32_dpp v64, v64, v64 row_ror:8 row_mask:0xf bank_mask:0xf
  v_mov_b32 v65, v64
  s_nop 1
  v_permlane16_swap_b32 v64, v65
  s_nop 0
  v_add_f32 v64, v64, v65
  v_mov_b32 v65, v64
  s_nop 1
  v_permlane32_swap_b32 v64, v65
  s_nop 0
  v_add_f32 v64, v64, v65
  ds_write_b32 v69, v64 offset:128
  s_waitcnt lgkmcnt(0)
  s_barrier
  ds_read_b128 v[64:67], v68 offset:128
  s_waitcnt lgkmcnt(0)
  v_pk_add_f32 v[64:65], v[64:65], v[66:67]
  v_add_f32 v64, v64, v65
  v_mov_b32 v65, 0x3727c5ac
  v_fmac_f32 v65, 0x3a800000, v64
  v_rsq_f32 v64, v65
  s_nop 0
  v_pk_mul_f32 v[32:33], v[32:33], v[64:65] op_sel_hi:[1,0]
  v_pk_mul_f32 v[34:35], v[34:35], v[64:65] op_sel_hi:[1,0]
  v_pk_mul_f32 v[36:37], v[36:37], v[64:65] op_sel_hi:[1,0]
  v_pk_mul_f32 v[38:39], v[38:39], v[64:65] op_sel_hi:[1,0]
  v_pk_mul_f32 v[40:41], v[40:41], v[64:65] op_sel_hi:[1,0]
  v_pk_mul_f32 v[42:43], v[42:43], v[64:65] op_sel_hi:[1,0]
  v_pk_mul_f32 v[44:45], v[44:45], v[64:65] op_sel_hi:[1,0]
  v_pk_mul_f32 v[46:47], v[46:47], v[64:65] op_sel_hi:[1,0]
  v_pk_mul_f32 v[48:49], v[48:49], v[64:65] op_sel_hi:[1,0]
  v_pk_mul_f32 v[50:51], v[50:51], v[64:65] op_sel_hi:[1,0]
  v_pk_mul_f32 v[52:53], v[52:53], v[64:65] op_sel_hi:[1,0]
  v_pk_mul_f32 v[54:55], v[54:55], v[64:65] op_sel_hi:[1,0]
  v_pk_mul_f32 v[56:57], v[56:57], v[64:65] op_sel_hi:[1,0]
  v_pk_mul_f32 v[58:59], v[58:59], v[64:65] op_sel_hi:[1,0]
  v_pk_mul_f32 v[60:61], v[60:61], v[64:65] op_sel_hi:[1,0]
  v_pk_mul_f32 v[62:63], v[62:63], v[64:65] op_sel_hi:[1,0]
  v_cvt_pk_bf16_f32 v16, v32, v33
  v_cvt_pk_bf16_f32 v17, v34, v35
  v_cvt_pk_bf16_f32 v18, v36, v37
  v_cvt_pk_bf16_f32 v19, v38, v39
  v_cvt_pk_bf16_f32 v20, v40, v41
  v_cvt_pk_bf16_f32 v21, v42, v43
  v_cvt_pk_bf16_f32 v22, v44, v45
  v_cvt_pk_bf16_f32 v23, v46, v47
  v_cvt_pk_bf16_f32 v24, v48, v49
  v_cvt_pk_bf16_f32 v25, v50, v51
  v_cvt_pk_bf16_f32 v26, v52, v53
  v_cvt_pk_bf16_f32 v27, v54, v55
  v_cvt_pk_bf16_f32 v28, v56, v57
  v_cvt_pk_bf16_f32 v29, v58, v59
  v_cvt_pk_bf16_f32 v30, v60, v61
  v_cvt_pk_bf16_f32 v31, v62, v63
  v_lshrrev_b32 v70, 5, v0
  v_lshlrev_b32 v70, 12, v70
  v_bfe_u32 v71, v0, 3, 1
  v_lshl_add_u32 v70, v71, 9, v70
  v_bfe_u32 v71, v0, 4, 1
  v_lshl_add_u32 v70, v71, 3, v70
  v_and_b32 v71, 7, v0
  v_lshl_add_u32 v70, v71, 4, v70
  s_add_u32 s56, s62, 0
  s_addc_u32 s57, s63, 0
  s_mov_b32 s58, 4194304
  s_mov_b32 s59, 0x00020000
  s_lshl_b32 s51, s49, 2
  s_lshr_b32 s52, s48, 3
  s_add_u32 s51, s51, s52
  s_lshl_b32 s51, s51, 17
  s_lshl_b32 s52, s47, 15
  s_add_u32 s51, s51, s52
  s_bfe_u32 s52, s48, 0x20001
  s_lshl_b32 s52, s52, 10
  s_add_u32 s51, s51, s52
  s_and_b32 s52, s48, 1
  s_lshl_b32 s52, s52, 7
  s_add_u32 s51, s51, s52
  buffer_store_dwordx2 v[16:17], v70, s[56:59], s51 offen sc1
  buffer_store_dwordx2 v[18:19], v70, s[56:59], s51 offen offset:256 sc1
  s_add_u32 s51, s51, 8192
  buffer_store_dwordx2 v[20:21], v70, s[56:59], s51 offen sc1
  buffer_store_dwordx2 v[22:23], v70, s[56:59], s51 offen offset:256 sc1
  s_add_u32 s51, s51, 8192
  buffer_store_dwordx2 v[24:25], v70, s[56:59], s51 offen sc1
  buffer_store_dwordx2 v[26:27], v70, s[56:59], s51 offen offset:256 sc1
  s_add_u32 s51, s51, 8192
  buffer_store_dwordx2 v[28:29], v70, s[56:59], s51 offen sc1
  buffer_store_dwordx2 v[30:31], v70, s[56:59], s51 offen offset:256 sc1
  v_lshrrev_b32 v10, 4, v0
  v_bfe_u32 v11, v0, 2, 2
  v_and_b32 v12, 3, v0
  v_lshl_add_u32 v13, v10, 2, v11
  v_mul_u32_u24 v9, 224, v13
  v_lshl_add_u32 v9, v12, 3, v9
  v_mul_u32_u24 v7, 192, v13
  v_and_b32 v14, 1, v12
  v_lshl_add_u32 v7, v14, 3, v7
  v_lshrrev_b32 v14, 1, v12
  v_lshl_add_u32 v7, v14, 4, v7
  v_and_b32 v14, 1, v10
  v_lshl_add_u32 v8, v14, 5, 0
  v_xor_b32 v15, 32, v8
  v_add_u32 v15, v15, v7
  v_add_u32 v7, v8, v7
  v_mov_b32 v8, v15
  v_mov_b32 v16, 0
  v_mov_b32 v17, 0
  v_mov_b32 v18, 0
  v_mov_b32 v19, 0
  v_mov_b32 v20, 0
  v_mov_b32 v21, 0
  v_mov_b32 v22, 0
  v_mov_b32 v23, 0
  v_mov_b32 v24, 0
  v_mov_b32 v25, 0
  v_mov_b32 v26, 0
  v_mov_b32 v27, 0
  v_mov_b32 v28, 0
  v_mov_b32 v29, 0
  v_mov_b32 v30, 0
  v_mov_b32 v31, 0
  v_mov_b32 v32, 0
  v_mov_b32 v33, 0
  v_mov_b32 v34, 0
  v_mov_b32 v35, 0
  v_mov_b32 v36, 0
  v_mov_b32 v37, 0
  v_mov_b32 v38, 0
  v_mov_b32 v39, 0
  v_mov_b32 v40, 0
  v_mov_b32 v41, 0
  v_mov_b32 v42, 0
  v_mov_b32 v43, 0
  v_mov_b32 v44, 0
  v_mov_b32 v45, 0
  v_mov_b32 v46, 0
  v_mov_b32 v47, 0
  v_mov_b32 v48, 0
  v_mov_b32 v49, 0
  v_mov_b32 v50, 0
  v_mov_b32 v51, 0
  v_mov_b32 v52, 0
  v_mov_b32 v53, 0
  v_mov_b32 v54, 0
  v_mov_b32 v55, 0
  v_mov_b32 v56, 0
  v_mov_b32 v57, 0
  v_mov_b32 v58, 0
  v_mov_b32 v59, 0
  v_mov_b32 v60, 0
  v_mov_b32 v61, 0
  v_mov_b32 v62, 0
  v_mov_b32 v63, 0
  v_mov_b32 v64, 0
  v_mov_b32 v65, 0
  v_mov_b32 v66, 0
  v_mov_b32 v67, 0
  v_mov_b32 v68, 0
  v_mov_b32 v69, 0
  v_mov_b32 v70, 0
  v_mov_b32 v71, 0
  v_mov_b32 v72, 0
  v_mov_b32 v73, 0
  v_mov_b32 v74, 0
  v_mov_b32 v75, 0
  v_mov_b32 v76, 0
  v_mov_b32 v77, 0
  v_mov_b32 v78, 0
  v_mov_b32 v79, 0
  v_mov_b32 v80, 0
  v_mov_b32 v81, 0
  v_mov_b32 v82, 0
  v_mov_b32 v83, 0
  v_mov_b32 v84, 0
  v_mov_b32 v85, 0
  v_mov_b32 v86, 0
  v_mov_b32 v87, 0
  v_mov_b32 v88, 0
  v_mov_b32 v89, 0
  v_mov_b32 v90, 0
  v_mov_b32 v91, 0
  v_mov_b32 v92, 0
  v_mov_b32 v93, 0
  v_mov_b32 v94, 0
  v_mov_b32 v95, 0
  v_mov_b32 v96, 0
  v_mov_b32 v97, 0
  v_mov_b32 v98, 0
  v_mov_b32 v99, 0
  v_mov_b32 v100, 0
  v_mov_b32 v101, 0
  v_mov_b32 v102, 0
  v_mov_b32 v103, 0
  v_mov_b32 v104, 0
  v_mov_b32 v105, 0
  v_mov_b32 v106, 0
  v_mov_b32 v107, 0
  v_mov_b32 v108, 0
  v_mov_b32 v109, 0
  v_mov_b32 v110, 0
  v_mov_b32 v111, 0
  v_mov_b32 v112, 0
  v_mov_b32 v113, 0
  v_mov_b32 v114, 0
  v_mov_b32 v115, 0
  v_mov_b32 v116, 0
  v_mov_b32 v117, 0
  v_mov_b32 v118, 0
  v_mov_b32 v119, 0
  v_mov_b32 v120, 0
  v_mov_b32 v121, 0
  v_mov_b32 v122, 0
  v_mov_b32 v123, 0
  v_mov_b32 v124, 0
  v_mov_b32 v125, 0
  v_mov_b32 v126, 0
  v_mov_b32 v127, 0
  v_mov_b32 v128, 0
  v_mov_b32 v129, 0
  v_mov_b32 v130, 0
  v_mov_b32 v131, 0
  v_mov_b32 v132, 0
  v_mov_b32 v133, 0
  v_mov_b32 v134, 0
  v_mov_b32 v135, 0
  v_mov_b32 v136, 0
  v_mov_b32 v137, 0
  v_mov_b32 v138, 0
  v_mov_b32 v139, 0
  v_mov_b32 v140, 0
  v_mov_b32 v141, 0
  v_mov_b32 v142, 0
  v_mov_b32 v143, 0
  v_mov_b32 v144, 0
  v_mov_b32 v145, 0
  v_mov_b32 v146, 0
  v_mov_b32 v147, 0
  v_mov_b32 v148, 0
  v_mov_b32 v149, 0
  v_mov_b32 v150, 0
  v_mov_b32 v151, 0
  v_mov_b32 v152, 0
  v_mov_b32 v153, 0
  v_mov_b32 v154, 0
  v_mov_b32 v155, 0
  v_mov_b32 v156, 0
  v_mov_b32 v157, 0
  v_mov_b32 v158, 0
  v_mov_b32 v159, 0
  v_mov_b32 v160, 0
  v_mov_b32 v161, 0
  v_mov_b32 v162, 0
  v_mov_b32 v163, 0
  v_mov_b32 v164, 0
  v_mov_b32 v165, 0
  v_mov_b32 v166, 0
  v_mov_b32 v167, 0
  v_mov_b32 v168, 0
  v_mov_b32 v169, 0
  v_mov_b32 v170, 0
  v_mov_b32 v171, 0
  v_mov_b32 v172, 0
  v_mov_b32 v173, 0
  v_mov_b32 v174, 0
  v_mov_b32 v175, 0
  v_mov_b32 v176, 0
  v_mov_b32 v177, 0
  v_mov_b32 v178, 0
  v_mov_b32 v179, 0
  v_mov_b32 v180, 0
  v_mov_b32 v181, 0
  v_mov_b32 v182, 0
  v_mov_b32 v183, 0
  v_mov_b32 v184, 0
  v_mov_b32 v185, 0
  v_mov_b32 v186, 0
  v_mov_b32 v187, 0
  v_mov_b32 v188, 0
  v_mov_b32 v189, 0
  v_mov_b32 v190, 0
  v_mov_b32 v191, 0
  v_mov_b32 v192, 0
  v_mov_b32 v193, 0
  v_mov_b32 v194, 0
  v_mov_b32 v195, 0
  v_mov_b32 v196, 0
  v_mov_b32 v197, 0
  v_mov_b32 v198, 0
  v_mov_b32 v199, 0
  v_mov_b32 v200, 0
  v_mov_b32 v201, 0
  v_mov_b32 v202, 0
  v_mov_b32 v203, 0
  v_mov_b32 v204, 0
  v_mov_b32 v205, 0
  v_mov_b32 v206, 0
  v_mov_b32 v207, 0
  v_mov_b32 v208, 0
  v_mov_b32 v209, 0
  v_mov_b32 v210, 0
  v_mov_b32 v211, 0
  v_mov_b32 v212, 0
  v_mov_b32 v213, 0
  v_mov_b32 v214, 0
  v_mov_b32 v215, 0
  v_mov_b32 v216, 0
  v_mov_b32 v217, 0
  v_mov_b32 v218, 0
  v_mov_b32 v219, 0
  v_mov_b32 v220, 0
  v_mov_b32 v221, 0
  v_mov_b32 v222, 0
  v_mov_b32 v223, 0
  v_mov_b32 v224, 0
  v_mov_b32 v225, 0
  v_mov_b32 v226, 0
  v_mov_b32 v227, 0
  v_mov_b32 v228, 0
  v_mov_b32 v229, 0
  v_mov_b32 v230, 0
  v_mov_b32 v231, 0
  v_mov_b32 v232, 0
  v_mov_b32 v233, 0
  v_mov_b32 v234, 0
  v_mov_b32 v235, 0
  v_mov_b32 v236, 0
  v_mov_b32 v237, 0
  v_mov_b32 v238, 0
  v_mov_b32 v239, 0
  v_mov_b32 v240, 0
  v_mov_b32 v241, 0
  v_mov_b32 v242, 0
  v_mov_b32 v243, 0
  v_mov_b32 v244, 0
  v_mov_b32 v245, 0
  v_mov_b32 v246, 0
  v_mov_b32 v247, 0
  v_mov_b32 v248, 0
  v_mov_b32 v249, 0
  v_mov_b32 v250, 0
  v_mov_b32 v251, 0
  v_mov_b32 v252, 0
  v_mov_b32 v253, 0
  v_mov_b32 v254, 0
  v_mov_b32 v255, 0
  v_accvgpr_write_b32 a0, 0
  v_accvgpr_write_b32 a1, 0
  v_accvgpr_write_b32 a2, 0
  v_accvgpr_write_b32 a3, 0
  v_accvgpr_write_b32 a4, 0
  v_accvgpr_write_b32 a5, 0
  v_accvgpr_write_b32 a6, 0
  v_accvgpr_write_b32 a7, 0
  v_accvgpr_write_b32 a8, 0
  v_accvgpr_write_b32 a9, 0
  v_accvgpr_write_b32 a10, 0
  v_accvgpr_write_b32 a11, 0
  v_accvgpr_write_b32 a12, 0
  v_accvgpr_write_b32 a13, 0
  v_accvgpr_write_b32 a14, 0
  v_accvgpr_write_b32 a15, 0
  v_accvgpr_write_b32 a16, 0
  v_accvgpr_write_b32 a17, 0
  v_accvgpr_write_b32 a18, 0
  v_accvgpr_write_b32 a19, 0
  v_accvgpr_write_b32 a20, 0
  v_accvgpr_write_b32 a21, 0
  v_accvgpr_write_b32 a22, 0
  v_accvgpr_write_b32 a23, 0
  v_accvgpr_write_b32 a24, 0
  v_accvgpr_write_b32 a25, 0
  v_accvgpr_write_b32 a26, 0
  v_accvgpr_write_b32 a27, 0
  v_accvgpr_write_b32 a28, 0
  v_accvgpr_write_b32 a29, 0
  v_accvgpr_write_b32 a30, 0
  v_accvgpr_write_b32 a31, 0
  v_accvgpr_write_b32 a32, 0
  v_accvgpr_write_b32 a33, 0
  v_accvgpr_write_b32 a34, 0
  v_accvgpr_write_b32 a35, 0
  v_accvgpr_write_b32 a36, 0
  v_accvgpr_write_b32 a37, 0
  v_accvgpr_write_b32 a38, 0
  v_accvgpr_write_b32 a39, 0
  v_accvgpr_write_b32 a40, 0
  v_accvgpr_write_b32 a41, 0
  v_accvgpr_write_b32 a42, 0
  v_accvgpr_write_b32 a43, 0
  v_accvgpr_write_b32 a44, 0
  v_accvgpr_write_b32 a45, 0
  v_accvgpr_write_b32 a46, 0
  v_accvgpr_write_b32 a47, 0
  v_accvgpr_write_b32 a48, 0
  v_accvgpr_write_b32 a49, 0
  v_accvgpr_write_b32 a50, 0
  v_accvgpr_write_b32 a51, 0
  v_accvgpr_write_b32 a52, 0
  v_accvgpr_write_b32 a53, 0
  v_accvgpr_write_b32 a54, 0
  v_accvgpr_write_b32 a55, 0
  v_accvgpr_write_b32 a56, 0
  v_accvgpr_write_b32 a57, 0
  v_accvgpr_write_b32 a58, 0
  v_accvgpr_write_b32 a59, 0
  v_accvgpr_write_b32 a60, 0
  v_accvgpr_write_b32 a61, 0
  v_accvgpr_write_b32 a62, 0
  v_accvgpr_write_b32 a63, 0
  v_accvgpr_write_b32 a64, 0
  v_accvgpr_write_b32 a65, 0
  v_accvgpr_write_b32 a66, 0
  v_accvgpr_write_b32 a67, 0
  v_accvgpr_write_b32 a68, 0
  v_accvgpr_write_b32 a69, 0
  v_accvgpr_write_b32 a70, 0
  v_accvgpr_write_b32 a71, 0
  v_accvgpr_write_b32 a72, 0
  v_accvgpr_write_b32 a73, 0
  v_accvgpr_write_b32 a74, 0
  v_accvgpr_write_b32 a75, 0
  v_accvgpr_write_b32 a76, 0
  v_accvgpr_write_b32 a77, 0
  v_accvgpr_write_b32 a78, 0
  v_accvgpr_write_b32 a79, 0
  s_cmp_lt_u32 s2, 8
  s_cbranch_scc0 L_k2_noclr
  s_add_u32 s56, s62, 37781504
  s_addc_u32 s57, s63, 0
  s_mov_b32 s58, 8192
  s_mov_b32 s59, 0x00020000
  s_lshl_b32 s51, s2, 10
  v_mov_b32 v12, s51
  v_mov_b32 v13, 0
  buffer_store_dword v13, v12, s[56:59], 0 offen
L_k2_noclr:
  s_cmp_eq_u32 s47, 0
  s_cbranch_scc0 L_k2_tagdone
  v_mov_b32 v10, 252
  s_mov_b32 s51, 200000
L_k2_tag:
  buffer_load_dword v11, v10, s[76:79], 0 offen sc1
  s_waitcnt vmcnt(0)
  v_readfirstlane_b32 s88, v11
  s_nop 0
  s_cmp_lg_u32 s88, 0
  s_cbranch_scc1 L_k2_tagdone
  s_sub_u32 s51, s51, 1
  s_cmp_eq_u32 s51, 0
  s_cbranch_scc0 L_k2_tag
L_k2_tagdone:
  s_waitcnt vmcnt(0)
  s_barrier
  s_cmp_eq_u32 s47, 0
  s_cbranch_scc0 L_k2_nopub
  s_add_u32 s76, s62, 37797888
  s_addc_u32 s77, s63, 0
  s_mov_b32 s78, 8192
  s_lshl_b32 s51, s49, 10
  s_lshl_b32 s52, s48, 2
  s_add_u32 s52, s52, s51
  v_mov_b32 v10, s52
  v_mov_b32 v11, s88
  s_mov_b64 exec, 1
  buffer_store_dword v11, v10, s[76:79], 0 offen sc1
  s_mov_b64 exec, -1
  v_and_b32 v10, 31, v0
  v_lshlrev_b32 v10, 2, v10
  v_add_u32 v10, s51, v10
L_k2_nopub:
  s_add_u32 m0, s43, 0
  s_mul_i32 s32, s73, s37
  buffer_load_dwordx4 v2, s[12:15], s32 offen lds
  s_add_u32 m0, s43, 1024
  s_mul_i32 s33, s73, s38
  buffer_load_dwordx4 v3, s[16:19], s33 offen lds
  s_add_u32 m0, s43, 2048
  s_mul_i32 s34, s73, s39
  buffer_load_dwordx4 v4, s[20:23], s34 offen lds
  s_add_u32 m0, s43, 3072
  s_mul_i32 s35, s73, s40
  buffer_load_dwordx4 v5, s[24:27], s35 offen lds
  s_add_u32 m0, s43, 4096
  s_mul_i32 s36, s73, s41
  buffer_load_dwordx4 v6, s[28:31], s36 offen lds
  s_lshl_b32 s42, s73, 12
  s_add_u32 s70, s70, 1
  s_and_b32 s70, s70, 7
  s_cmp_eq_u32 s70, s72
  s_cselect_b32 s51, 8, 0
  s_add_u32 s71, s71, s51
  s_add_u32 s73, s71, s70
  s_cmp_eq_u32 s43, s44
  s_cselect_b32 s51, s66, s67
  s_add_u32 s43, s43, s51
  s_mov_b32 s94, s42
  s_cmp_eq_u32 s47, 0
  s_cbranch_scc1 L_k2_dopoll
  s_add_u32 m0, s43, 0
  s_mul_i32 s32, s73, s37
  buffer_load_dwordx4 v2, s[12:15], s32 offen lds
  s_add_u32 m0, s43, 1024
  s_mul_i32 s33, s73, s38
  buffer_load_dwordx4 v3, s[16:19], s33 offen lds
  s_add_u32 m0, s43, 2048
  s_mul_i32 s34, s73, s39
  buffer_load_dwordx4 v4, s[20:23], s34 offen lds
  s_add_u32 m0, s43, 3072
  s_mul_i32 s35, s73, s40
  buffer_load_dwordx4 v5, s[24:27], s35 offen lds
  s_add_u32 m0, s43, 4096
  s_mul_i32 s36, s73, s41
  buffer_load_dwordx4 v6, s[28:31], s36 offen lds
  s_lshl_b32 s42, s73, 12
  s_add_u32 s70, s70, 1
  s_and_b32 s70, s70, 7
  s_cmp_eq_u32 s70, s72
  s_cselect_b32 s51, 8, 0
  s_add_u32 s71, s71, s51
  s_add_u32 s73, s71, s70
  s_cmp_eq_u32 s43, s44
  s_cselect_b32 s51, s66, s67
  s_add_u32 s43, s43, s51
  s_mov_b32 s93, s42
  s_add_u32 m0, s43, 0
  s_mul_i32 s32, s73, s37
  buffer_load_dwordx4 v2, s[12:15], s32 offen lds
  s_add_u32 m0, s43, 1024
  s_mul_i32 s33, s73, s38
  buffer_load_dwordx4 v3, s[16:19], s33 offen lds
  s_add_u32 m0, s43, 2048
  s_mul_i32 s34, s73, s39
  buffer_load_dwordx4 v4, s[20:23], s34 offen lds
  s_add_u32 m0, s43, 3072
  s_mul_i32 s35, s73, s40
  buffer_load_dwordx4 v5, s[24:27], s35 offen lds
  s_add_u32 m0, s43, 4096
  s_mul_i32 s36, s73, s41
  buffer_load_dwordx4 v6, s[28:31], s36 offen lds
  s_lshl_b32 s42, s73, 12
  s_add_u32 s70, s70, 1
  s_and_b32 s70, s70, 7
  s_cmp_eq_u32 s70, s72
  s_cselect_b32 s51, 8, 0
  s_add_u32 s71, s71, s51
  s_add_u32 s73, s71, s70
  s_cmp_eq_u32 s43, s44
  s_cselect_b32 s51, s66, s67
  s_add_u32 s43, s43, s51
  s_mov_b32 s92, s42
  s_lshl_b32 s51, s48, 11
  s_add_u32 s56, s64, s51
  s_addc_u32 s57, s65, 0
  s_mov_b32 s58, 2048
  s_mov_b32 s59, 0x00020000
  s_mov_b32 m0, 102400
  s_nop 0
  buffer_load_dwordx4 v1, s[56:59], 0 offen lds
  buffer_load_dwordx4 v1, s[56:59], 0 offen offset:1024 lds
  s_branch L_k2_nopoll
L_k2_dopoll:
  s_mov_b32 s51, 200000
L_k2_poll:
  buffer_load_dword v11, v10, s[76:79], 0 offen sc1
  s_waitcnt vmcnt(0)
  v_cmp_ne_u32 vcc, s88, v11
  s_nop 0
  s_cmp_eq_u64 vcc, 0
  s_cbranch_scc1 L_k2_polled
  s_sub_u32 s51, s51, 1
  s_cmp_eq_u32 s51, 0
  s_cbranch_scc1 L_k2_polled
  s_sleep 2
  s_branch L_k2_poll
L_k2_polled:
  s_barrier
  s_mov_b32 s42, s95
  buffer_load_dwordx4 a[80:83], v1, s[8:11], s42 offen offset:0 sc1
  buffer_load_dwordx4 a[84:87], v1, s[8:11], s42 offen offset:1024 sc1
  buffer_load_dwordx4 a[88:91], v1, s[8:11], s42 offen offset:2048 sc1
  buffer_load_dwordx4 a[92:95], v1, s[8:11], s42 offen offset:3072 sc1
  s_add_u32 m0, s43, 0
  s_mul_i32 s32, s73, s37
  buffer_load_dwordx4 v2, s[12:15], s32 offen lds
  s_add_u32 m0, s43, 1024
  s_mul_i32 s33, s73, s38
  buffer_load_dwordx4 v3, s[16:19], s33 offen lds
  s_add_u32 m0, s43, 2048
  s_mul_i32 s34, s73, s39
  buffer_load_dwordx4 v4, s[20:23], s34 offen lds
  s_add_u32 m0, s43, 3072
  s_mul_i32 s35, s73, s40
  buffer_load_dwordx4 v5, s[24:27], s35 offen lds
  s_add_u32 m0, s43, 4096
  s_mul_i32 s36, s73, s41
  buffer_load_dwordx4 v6, s[28:31], s36 offen lds
  s_lshl_b32 s42, s73, 12
  s_add_u32 s70, s70, 1
  s_and_b32 s70, s70, 7
  s_cmp_eq_u32 s70, s72
  s_cselect_b32 s51, 8, 0
  s_add_u32 s71, s71, s51
  s_add_u32 s73, s71, s70
  s_cmp_eq_u32 s43, s44
  s_cselect_b32 s51, s66, s67
  s_add_u32 s43, s43, s51
  s_mov_b32 s93, s42
  s_add_u32 m0, s43, 0
  s_mul_i32 s32, s73, s37
  buffer_load_dwordx4 v2, s[12:15], s32 offen lds
  s_add_u32 m0, s43, 1024
  s_mul_i32 s33, s73, s38
  buffer_load_dwordx4 v3, s[16:19], s33 offen lds
  s_add_u32 m0, s43, 2048
  s_mul_i32 s34, s73, s39
  buffer_load_dwordx4 v4, s[20:23], s34 offen lds
  s_add_u32 m0, s43, 3072
  s_mul_i32 s35, s73, s40
  buffer_load_dwordx4 v5, s[24:27], s35 offen lds
  s_add_u32 m0, s43, 4096
  s_mul_i32 s36, s73, s41
  buffer_load_dwordx4 v6, s[28:31], s36 offen lds
  s_lshl_b32 s42, s73, 12
  s_add_u32 s70, s70, 1
  s_and_b32 s70, s70, 7
  s_cmp_eq_u32 s70, s72
  s_cselect_b32 s51, 8, 0
  s_add_u32 s71, s71, s51
  s_add_u32 s73, s71, s70
  s_cmp_eq_u32 s43, s44
  s_cselect_b32 s51, s66, s67
  s_add_u32 s43, s43, s51
  s_mov_b32 s92, s42
  s_lshl_b32 s51, s48, 11
  s_add_u32 s56, s64, s51
  s_addc_u32 s57, s65, 0
  s_mov_b32 s58, 2048
  s_mov_b32 s59, 0x00020000
  s_mov_b32 m0, 102400
  s_nop 0
  buffer_load_dwordx4 v1, s[56:59], 0 offen lds
  buffer_load_dwordx4 v1, s[56:59], 0 offen offset:1024 lds
  s_mov_b32 s42, s94
  buffer_load_dwordx4 a[96:99], v1, s[8:11], s42 offen offset:0 sc1
  buffer_load_dwordx4 a[100:103], v1, s[8:11], s42 offen offset:1024 sc1
  buffer_load_dwordx4 a[104:107], v1, s[8:11], s42 offen offset:2048 sc1
  buffer_load_dwordx4 a[108:111], v1, s[8:11], s42 offen offset:3072 sc1
  s_mov_b32 s42, s93
  buffer_load_dwordx4 a[112:115], v1, s[8:11], s42 offen offset:0 sc1
  buffer_load_dwordx4 a[116:119], v1, s[8:11], s42 offen offset:1024 sc1
  buffer_load_dwordx4 a[120:123], v1, s[8:11], s42 offen offset:2048 sc1
  buffer_load_dwordx4 a[124:127], v1, s[8:11], s42 offen offset:3072 sc1
  s_mov_b32 s42, s92
  s_load_dwordx2 s[76:77], s[0:1], 56
  s_load_dwordx2 s[80:81], s[0:1], 24
  s_lshl_b32 s52, s2, 2
  s_add_u32 s52, s52, s47
  v_lshlrev_b32 v10, 7, v0
  v_and_b32 v11, 0x7ff, v10
  s_mov_b32 s78, 7340032
  s_mov_b32 s79, 0x00020000
  s_mov_b32 s82, 2097152
  s_mov_b32 s83, 0x00020000
  s_mul_i32 s74, s52, 7168
  s_lshl_b32 s75, s52, 11
  s_add_u32 s84, s62, 41943040
  s_addc_u32 s85, s63, 0
  s_mov_b32 s86, 4194304
  s_mov_b32 s87, 0x00020000
  s_lshl_b32 s88, s52, 12
  s_lshr_b32 s89, s2, 3
  s_mul_i32 s52, s89, 43
  s_lshr_b32 s52, s52, 8
  s_mul_i32 s52, s52, 6
  s_sub_u32 s89, s89, s52
  s_add_u32 s89, s89, 1
  v_mov_b32 v12, -1
  v_mov_b32 v13, -1
  v_mov_b32 v14, -1
  v_mov_b32 v15, -1
  s_waitcnt lgkmcnt(0)
  s_waitcnt vmcnt(20)
  s_branch L_k2_join
L_k2_nopoll:
  s_barrier
L_k2_go:
  s_mov_b32 s42, s95
  buffer_load_dwordx4 a[80:83], v1, s[8:11], s42 offen offset:0 sc1
  buffer_load_dwordx4 a[84:87], v1, s[8:11], s42 offen offset:1024 sc1
  buffer_load_dwordx4 a[88:91], v1, s[8:11], s42 offen offset:2048 sc1
  buffer_load_dwordx4 a[92:95], v1, s[8:11], s42 offen offset:3072 sc1
  s_mov_b32 s42, s94
  buffer_load_dwordx4 a[96:99], v1, s[8:11], s42 offen offset:0 sc1
  buffer_load_dwordx4 a[100:103], v1, s[8:11], s42 offen offset:1024 sc1
  buffer_load_dwordx4 a[104:107], v1, s[8:11], s42 offen offset:2048 sc1
  buffer_load_dwordx4 a[108:111], v1, s[8:11], s42 offen offset:3072 sc1
  s_mov_b32 s42, s93
  buffer_load_dwordx4 a[112:115], v1, s[8:11], s42 offen offset:0 sc1
  buffer_load_dwordx4 a[116:119], v1, s[8:11], s42 offen offset:1024 sc1
  buffer_load_dwordx4 a[120:123], v1, s[8:11], s42 offen offset:2048 sc1
  buffer_load_dwordx4 a[124:127], v1, s[8:11], s42 offen offset:3072 sc1
  s_mov_b32 s42, s92
  s_load_dwordx2 s[76:77], s[0:1], 56
  s_load_dwordx2 s[80:81], s[0:1], 24
  s_lshl_b32 s52, s2, 2
  s_add_u32 s52, s52, s47
  v_lshlrev_b32 v10, 7, v0
  v_and_b32 v11, 0x7ff, v10
  s_mov_b32 s78, 7340032
  s_mov_b32 s79, 0x00020000
  s_mov_b32 s82, 2097152
  s_mov_b32 s83, 0x00020000
  s_mul_i32 s74, s52, 7168
  s_lshl_b32 s75, s52, 11
  s_add_u32 s84, s62, 41943040
  s_addc_u32 s85, s63, 0
  s_mov_b32 s86, 4194304
  s_mov_b32 s87, 0x00020000
  s_lshl_b32 s88, s52, 12
  s_lshr_b32 s89, s2, 3
  s_mul_i32 s52, s89, 43
  s_lshr_b32 s52, s52, 8
  s_mul_i32 s52, s52, 6
  s_sub_u32 s89, s89, s52
  s_add_u32 s89, s89, 1
  v_mov_b32 v12, -1
  v_mov_b32 v13, -1
  v_mov_b32 v14, -1
  v_mov_b32 v15, -1
  s_waitcnt lgkmcnt(0)
  s_waitcnt vmcnt(8)
L_k2_join:
  s_barrier
  ds_read_b64_tr_b16 a[144:145], v7 offset:0
  ds_read_b64_tr_b16 a[146:147], v7 offset:3072
  ds_read_b64_tr_b16 a[148:149], v8 offset:0
  ds_read_b64_tr_b16 a[150:151], v8 offset:3072
  ds_read_b64_tr_b16 a[152:153], v7 offset:64
  ds_read_b64_tr_b16 a[154:155], v7 offset:3136
  ds_read_b64_tr_b16 a[156:157], v8 offset:64
  ds_read_b64_tr_b16 a[158:159], v8 offset:3136
  s_mov_b32 s46, 0
L_k2_loop:
  s_waitcnt vmcnt(18)
  s_barrier
  s_waitcnt lgkmcnt(6)
  v_mfma_f32_16x16x32_bf16 v[16:19], a[144:147], a[80:83], v[16:19]
  ds_read_b64_tr_b16 a[160:161], v7 offset:128
  v_mfma_f32_16x16x32_bf16 v[96:99], a[144:147], a[84:87], v[96:99]
  v_mfma_f32_16x16x32_bf16 v[176:179], a[144:147], a[88:91], v[176:179]
  ds_read_b64_tr_b16 a[162:163], v7 offset:3200
  v_mfma_f32_16x16x32_bf16 a[0:3], a[144:147], a[92:95], a[0:3]
  s_mul_i32 s32, s73, s37
  s_waitcnt lgkmcnt(6)
  v_mfma_f32_16x16x32_bf16 a[4:7], a[148:151], a[92:95], a[4:7]
  ds_read_b64_tr_b16 a[164:165], v8 offset:128
  v_mfma_f32_16x16x32_bf16 v[180:183], a[148:151], a[88:91], v[180:183]
  s_add_u32 m0, s43, 0
  v_mfma_f32_16x16x32_bf16 v[100:103], a[148:151], a[84:87], v[100:103]
  ds_read_b64_tr_b16 a[166:167], v8 offset:3200
  v_mfma_f32_16x16x32_bf16 v[20:23], a[148:151], a[80:83], v[20:23]
  buffer_load_dwordx4 v2, s[12:15], s32 offen lds
  s_waitcnt lgkmcnt(6)
  v_mfma_f32_16x16x32_bf16 v[24:27], a[152:155], a[80:83], v[24:27]
  ds_read_b64_tr_b16 a[168:169], v9 offset:6144
  v_mfma_f32_16x16x32_bf16 v[104:107], a[152:155], a[84:87], v[104:107]
  v_mfma_f32_16x16x32_bf16 v[184:187], a[152:155], a[88:91], v[184:187]
  ds_read_b64_tr_b16 a[170:171], v9 offset:9728
  v_mfma_f32_16x16x32_bf16 a[8:11], a[152:155], a[92:95], a[8:11]
  s_mul_i32 s33, s73, s38
  s_waitcnt lgkmcnt(6)
  v_mfma_f32_16x16x32_bf16 a[12:15], a[156:159], a[92:95], a[12:15]
  ds_read_b64_tr_b16 a[172:173], v9 offset:13312
  v_mfma_f32_16x16x32_bf16 v[188:191], a[156:159], a[88:91], v[188:191]
  s_add_u32 m0, s43, 1024
  v_mfma_f32_16x16x32_bf16 v[108:111], a[156:159], a[84:87], v[108:111]
  ds_read_b64_tr_b16 a[174:175], v9 offset:16896
  v_mfma_f32_16x16x32_bf16 v[28:31], a[156:159], a[80:83], v[28:31]
  buffer_load_dwordx4 v3, s[16:19], s33 offen lds
  s_waitcnt lgkmcnt(6)
  v_mfma_f32_16x16x32_bf16 v[32:35], a[80:83], a[160:163], v[32:35]
  ds_read_b64_tr_b16 a[176:177], v9 offset:6176
  v_mfma_f32_16x16x32_bf16 v[112:115], a[84:87], a[160:163], v[112:115]
  v_mfma_f32_16x16x32_bf16 v[192:195], a[88:91], a[160:163], v[192:195]
  ds_read_b64_tr_b16 a[178:179], v9 offset:9760
  v_mfma_f32_16x16x32_bf16 a[16:19], a[92:95], a[160:163], a[16:19]
  s_mul_i32 s34, s73, s39
  s_waitcnt lgkmcnt(6)
  v_mfma_f32_16x16x32_bf16 a[20:23], a[92:95], a[164:167], a[20:23]
  ds_read_b64_tr_b16 a[180:181], v9 offset:13344
  v_mfma_f32_16x16x32_bf16 v[196:199], a[88:91], a[164:167], v[196:199]
  s_add_u32 m0, s43, 2048
  v_mfma_f32_16x16x32_bf16 v[116:119], a[84:87], a[164:167], v[116:119]
  ds_read_b64_tr_b16 a[182:183], v9 offset:16928
  v_mfma_f32_16x16x32_bf16 v[36:39], a[80:83], a[164:167], v[36:39]
  buffer_load_dwordx4 v4, s[20:23], s34 offen lds
  s_waitcnt lgkmcnt(6)
  v_mfma_f32_16x16x32_bf16 v[40:43], a[168:171], a[80:83], v[40:43]
  ds_read_b64_tr_b16 a[144:145], v9 offset:6208
  v_mfma_f32_16x16x32_bf16 v[120:123], a[168:171], a[84:87], v[120:123]
  v_mfma_f32_16x16x32_bf16 v[200:203], a[168:171], a[88:91], v[200:203]
  ds_read_b64_tr_b16 a[146:147], v9 offset:9792
  v_mfma_f32_16x16x32_bf16 a[24:27], a[168:171], a[92:95], a[24:27]
  s_mul_i32 s35, s73, s40
  s_waitcnt lgkmcnt(6)
  v_mfma_f32_16x16x32_bf16 a[28:31], a[172:175], a[92:95], a[28:31]
  ds_read_b64_tr_b16 a[148:149], v9 offset:13376
  v_mfma_f32_16x16x32_bf16 v[204:207], a[172:175], a[88:91], v[204:207]
  s_add_u32 m0, s43, 3072
  v_mfma_f32_16x16x32_bf16 v[124:127], a[172:175], a[84:87], v[124:127]
  ds_read_b64_tr_b16 a[150:151], v9 offset:16960
  v_mfma_f32_16x16x32_bf16 v[44:47], a[172:175], a[80:83], v[44:47]
  buffer_load_dwordx4 v5, s[24:27], s35 offen lds
  s_cmp_eq_u32 s45, 81920
  s_cselect_b32 s50, s66, s67
  s_waitcnt lgkmcnt(6)
  v_mfma_f32_16x16x32_bf16 v[48:51], a[176:179], a[80:83], v[48:51]
  ds_read_b64_tr_b16 a[152:153], v9 offset:6240
  v_mfma_f32_16x16x32_bf16 v[128:131], a[176:179], a[84:87], v[128:131]
  v_mfma_f32_16x16x32_bf16 v[208:211], a[176:179], a[88:91], v[208:211]
  ds_read_b64_tr_b16 a[154:155], v9 offset:9824
  v_mfma_f32_16x16x32_bf16 a[32:35], a[176:179], a[92:95], a[32:35]
  s_mul_i32 s36, s73, s41
  s_add_u32 s45, s45, s50
  s_waitcnt lgkmcnt(6)
  v_mfma_f32_16x16x32_bf16 a[36:39], a[180:183], a[92:95], a[36:39]
  ds_read_b64_tr_b16 a[156:157], v9 offset:13408
  v_mfma_f32_16x16x32_bf16 v[212:215], a[180:183], a[88:91], v[212:215]
  s_add_u32 m0, s43, 4096
  v_add_u32 v7, s50, v7
  v_mfma_f32_16x16x32_bf16 v[132:135], a[180:183], a[84:87], v[132:135]
  ds_read_b64_tr_b16 a[158:159], v9 offset:16992
  v_mfma_f32_16x16x32_bf16 v[52:55], a[180:183], a[80:83], v[52:55]
  buffer_load_dwordx4 v6, s[28:31], s36 offen lds
  v_add_u32 v8, s50, v8
  s_waitcnt lgkmcnt(6)
  v_mfma_f32_16x16x32_bf16 v[56:59], a[144:147], a[80:83], v[56:59]
  ds_read_b64_tr_b16 a[160:161], v9 offset:6272
  v_mfma_f32_16x16x32_bf16 v[136:139], a[144:147], a[84:87], v[136:139]
  v_mfma_f32_16x16x32_bf16 v[216:219], a[144:147], a[88:91], v[216:219]
  ds_read_b64_tr_b16 a[162:163], v9 offset:9856
  v_mfma_f32_16x16x32_bf16 a[40:43], a[144:147], a[92:95], a[40:43]
  s_waitcnt lgkmcnt(6)
  v_mfma_f32_16x16x32_bf16 a[44:47], a[148:151], a[92:95], a[44:47]
  ds_read_b64_tr_b16 a[164:165], v9 offset:13440
  v_mfma_f32_16x16x32_bf16 v[220:223], a[148:151], a[88:91], v[220:223]
  buffer_load_dwordx4 a[128:131], v1, s[8:11], s42 offen offset:0 sc1
  v_mfma_f32_16x16x32_bf16 v[140:143], a[148:151], a[84:87], v[140:143]
  ds_read_b64_tr_b16 a[166:167], v9 offset:17024
  v_mfma_f32_16x16x32_bf16 v[60:63], a[148:151], a[80:83], v[60:63]
  s_waitcnt lgkmcnt(6)
  v_mfma_f32_16x16x32_bf16 v[64:67], a[152:155], a[80:83], v[64:67]
  ds_read_b64_tr_b16 a[168:169], v9 offset:6304
  v_mfma_f32_16x16x32_bf16 v[144:147], a[152:155], a[84:87], v[144:147]
  v_mfma_f32_16x16x32_bf16 v[224:227], a[152:155], a[88:91], v[224:227]
  ds_read_b64_tr_b16 a[170:171], v9 offset:9888
  v_mfma_f32_16x16x32_bf16 a[48:51], a[152:155], a[92:95], a[48:51]
  s_waitcnt lgkmcnt(6)
  v_mfma_f32_16x16x32_bf16 a[52:55], a[156:159], a[92:95], a[52:55]
  ds_read_b64_tr_b16 a[172:173], v9 offset:13472
  v_mfma_f32_16x16x32_bf16 v[228:231], a[156:159], a[88:91], v[228:231]
  buffer_load_dwordx4 a[132:135], v1, s[8:11], s42 offen offset:1024 sc1
  v_mfma_f32_16x16x32_bf16 v[148:151], a[156:159], a[84:87], v[148:151]
  ds_read_b64_tr_b16 a[174:175], v9 offset:17056
  v_mfma_f32_16x16x32_bf16 v[68:71], a[156:159], a[80:83], v[68:71]
  s_waitcnt lgkmcnt(6)
  v_mfma_f32_16x16x32_bf16 v[72:75], a[160:163], a[80:83], v[72:75]
  ds_read_b64_tr_b16 a[176:177], v9 offset:6336
  v_mfma_f32_16x16x32_bf16 v[152:155], a[160:163], a[84:87], v[152:155]
  v_mfma_f32_16x16x32_bf16 v[232:235], a[160:163], a[88:91], v[232:235]
  ds_read_b64_tr_b16 a[178:179], v9 offset:9920
  v_mfma_f32_16x16x32_bf16 a[56:59], a[160:163], a[92:95], a[56:59]
  s_waitcnt lgkmcnt(6)
  v_mfma_f32_16x16x32_bf16 a[60:63], a[164:167], a[92:95], a[60:63]
  ds_read_b64_tr_b16 a[180:181], v9 offset:13504
  v_mfma_f32_16x16x32_bf16 v[236:239], a[164:167], a[88:91], v[236:239]
  buffer_load_dwordx4 a[136:139], v1, s[8:11], s42 offen offset:2048 sc1
  v_mfma_f32_16x16x32_bf16 v[156:159], a[164:167], a[84:87], v[156:159]
  ds_read_b64_tr_b16 a[182:183], v9 offset:17088
  v_mfma_f32_16x16x32_bf16 v[76:79], a[164:167], a[80:83], v[76:79]
  v_add_u32 v9, s50, v9
  s_waitcnt lgkmcnt(6)
  v_mfma_f32_16x16x32_bf16 v[80:83], a[168:171], a[80:83], v[80:83]
  ds_read_b64_tr_b16 a[144:145], v7 offset:0
  v_mfma_f32_16x16x32_bf16 v[160:163], a[168:171], a[84:87], v[160:163]
  v_mfma_f32_16x16x32_bf16 v[240:243], a[168:171], a[88:91], v[240:243]
  ds_read_b64_tr_b16 a[146:147], v7 offset:3072
  v_mfma_f32_16x16x32_bf16 a[64:67], a[168:171], a[92:95], a[64:67]
  s_waitcnt lgkmcnt(6)
  v_mfma_f32_16x16x32_bf16 a[68:71], a[172:175], a[92:95], a[68:71]
  ds_read_b64_tr_b16 a[148:149], v8 offset:0
  v_mfma_f32_16x16x32_bf16 v[244:247], a[172:175], a[88:91], v[244:247]
  buffer_load_dwordx4 a[140:143], v1, s[8:11], s42 offen offset:3072 sc1
  v_mfma_f32_16x16x32_bf16 v[164:167], a[172:175], a[84:87], v[164:167]
  ds_read_b64_tr_b16 a[150:151], v8 offset:3072
  v_mfma_f32_16x16x32_bf16 v[84:87], a[172:175], a[80:83], v[84:87]
  s_waitcnt lgkmcnt(6)
  v_mfma_f32_16x16x32_bf16 v[88:91], a[176:179], a[80:83], v[88:91]
  ds_read_b64_tr_b16 a[152:153], v7 offset:64
  v_mfma_f32_16x16x32_bf16 v[168:171], a[176:179], a[84:87], v[168:171]
  s_lshl_b32 s42, s73, 12
  s_add_u32 s70, s70, 1
  s_and_b32 s70, s70, 7
  v_mfma_f32_16x16x32_bf16 v[248:251], a[176:179], a[88:91], v[248:251]
  ds_read_b64_tr_b16 a[154:155], v7 offset:3136
  v_mfma_f32_16x16x32_bf16 a[72:75], a[176:179], a[92:95], a[72:75]
  s_cmp_eq_u32 s70, s72
  s_cselect_b32 s51, 8, 0
  s_add_u32 s71, s71, s51
  s_add_u32 s73, s71, s70
  s_waitcnt lgkmcnt(6)
  v_mfma_f32_16x16x32_bf16 a[76:79], a[180:183], a[92:95], a[76:79]
  ds_read_b64_tr_b16 a[156:157], v8 offset:64
  v_mfma_f32_16x16x32_bf16 v[252:255], a[180:183], a[88:91], v[252:255]
  s_cmp_eq_u32 s43, s44
  s_cselect_b32 s51, s66, s67
  s_add_u32 s43, s43, s51
  v_mfma_f32_16x16x32_bf16 v[172:175], a[180:183], a[84:87], v[172:175]
  ds_read_b64_tr_b16 a[158:159], v8 offset:3136
  v_mfma_f32_16x16x32_bf16 v[92:95], a[180:183], a[80:83], v[92:95]
  s_waitcnt vmcnt(13)
  s_barrier
  s_waitcnt lgkmcnt(6)
  v_mfma_f32_16x16x32_bf16 v[16:19], a[144:147], a[96:99], v[16:19]
  ds_read_b64_tr_b16 a[160:161], v7 offset:128
  v_mfma_f32_16x16x32_bf16 v[96:99], a[144:147], a[100:103], v[96:99]
  v_mfma_f32_16x16x32_bf16 v[176:179], a[144:147], a[104:107], v[176:179]
  ds_read_b64_tr_b16 a[162:163], v7 offset:3200
  v_mfma_f32_16x16x32_bf16 a[0:3], a[144:147], a[108:111], a[0:3]
  s_mul_i32 s32, s73, s37
  s_waitcnt lgkmcnt(6)
  v_mfma_f32_16x16x32_bf16 a[4:7], a[148:151], a[108:111], a[4:7]
  ds_read_b64_tr_b16 a[164:165], v8 offset:128
  v_mfma_f32_16x16x32_bf16 v[180:183], a[148:151], a[104:107], v[180:183]
  s_add_u32 m0, s43, 0
  v_mfma_f32_16x16x32_bf16 v[100:103], a[148:151], a[100:103], v[100:103]
  ds_read_b64_tr_b16 a[166:167], v8 offset:3200
  v_mfma_f32_16x16x32_bf16 v[20:23], a[148:151], a[96:99], v[20:23]
  buffer_load_dwordx4 v2, s[12:15], s32 offen lds
  s_waitcnt lgkmcnt(6)
  v_mfma_f32_16x16x32_bf16 v[24:27], a[152:155], a[96:99], v[24:27]
  ds_read_b64_tr_b16 a[168:169], v9 offset:6144
  v_mfma_f32_16x16x32_bf16 v[104:107], a[152:155], a[100:103], v[104:107]
  v_mfma_f32_16x16x32_bf16 v[184:187], a[152:155], a[104:107], v[184:187]
  ds_read_b64_tr_b16 a[170:171], v9 offset:9728
  v_mfma_f32_16x16x32_bf16 a[8:11], a[152:155], a[108:111], a[8:11]
  s_mul_i32 s33, s73, s38
  s_waitcnt lgkmcnt(6)
  v_mfma_f32_16x16x32_bf16 a[12:15], a[156:159], a[108:111], a[12:15]
  ds_read_b64_tr_b16 a[172:173], v9 offset:13312
  v_mfma_f32_16x16x32_bf16 v[188:191], a[156:159], a[104:107], v[188:191]
  s_add_u32 m0, s43, 1024
  v_mfma_f32_16x16x32_bf16 v[108:111], a[156:159], a[100:103], v[108:111]
  ds_read_b64_tr_b16 a[174:175], v9 offset:16896
  v_mfma_f32_16x16x32_bf16 v[28:31], a[156:159], a[96:99], v[28:31]
  buffer_load_dwordx4 v3, s[16:19], s33 offen lds
  s_waitcnt lgkmcnt(6)
  v_mfma_f32_16x16x32_bf16 v[32:35], a[96:99], a[160:163], v[32:35]
  ds_read_b64_tr_b16 a[176:177], v9 offset:6176
  v_mfma_f32_16x16x32_bf16 v[112:115], a[100:103], a[160:163], v[112:115]
  v_mfma_f32_16x16x32_bf16 v[192:195], a[104:107], a[160:163], v[192:195]
  ds_read_b64_tr_b16 a[178:179], v9 offset:9760
  v_mfma_f32_16x16x32_bf16 a[16:19], a[108:111], a[160:163], a[16:19]
  s_mul_i32 s34, s73, s39
  s_waitcnt lgkmcnt(6)
  v_mfma_f32_16x16x32_bf16 a[20:23], a[108:111], a[164:167], a[20:23]
  ds_read_b64_tr_b16 a[180:181], v9 offset:13344
  v_mfma_f32_16x16x32_bf16 v[196:199], a[104:107], a[164:167], v[196:199]
  s_add_u32 m0, s43, 2048
  v_mfma_f32_16x16x32_bf16 v[116:119], a[100:103], a[164:167], v[116:119]
  ds_read_b64_tr_b16 a[182:183], v9 offset:16928
  v_mfma_f32_16x16x32_bf16 v[36:39], a[96:99], a[164:167], v[36:39]
  buffer_load_dwordx4 v4, s[20:23], s34 offen lds
  s_waitcnt lgkmcnt(6)
  v_mfma_f32_16x16x32_bf16 v[40:43], a[168:171], a[96:99], v[40:43]
  ds_read_b64_tr_b16 a[144:145], v9 offset:6208
  v_mfma_f32_16x16x32_bf16 v[120:123], a[168:171], a[100:103], v[120:123]
  v_mfma_f32_16x16x32_bf16 v[200:203], a[168:171], a[104:107], v[200:203]
  ds_read_b64_tr_b16 a[146:147], v9 offset:9792
  v_mfma_f32_16x16x32_bf16 a[24:27], a[168:171], a[108:111], a[24:27]
  s_mul_i32 s35, s73, s40
  s_waitcnt lgkmcnt(6)
  v_mfma_f32_16x16x32_bf16 a[28:31], a[172:175], a[108:111], a[28:31]
  ds_read_b64_tr_b16 a[148:149], v9 offset:13376
  v_mfma_f32_16x16x32_bf16 v[204:207], a[172:175], a[104:107], v[204:207]
  s_add_u32 m0, s43, 3072
  v_mfma_f32_16x16x32_bf16 v[124:127], a[172:175], a[100:103], v[124:127]
  ds_read_b64_tr_b16 a[150:151], v9 offset:16960
  v_mfma_f32_16x16x32_bf16 v[44:47], a[172:175], a[96:99], v[44:47]
  buffer_load_dwordx4 v5, s[24:27], s35 offen lds
  s_cmp_eq_u32 s45, 81920
  s_cselect_b32 s50, s66, s67
  s_waitcnt lgkmcnt(6)
  v_mfma_f32_16x16x32_bf16 v[48:51], a[176:179], a[96:99], v[48:51]
  ds_read_b64_tr_b16 a[152:153], v9 offset:6240
  v_mfma_f32_16x16x32_bf16 v[128:131], a[176:179], a[100:103], v[128:131]
  v_mfma_f32_16x16x32_bf16 v[208:211], a[176:179], a[104:107], v[208:211]
  ds_read_b64_tr_b16 a[154:155], v9 offset:9824
  v_mfma_f32_16x16x32_bf16 a[32:35], a[176:179], a[108:111], a[32:35]
  s_mul_i32 s36, s73, s41
  s_add_u32 s45, s45, s50
  s_waitcnt lgkmcnt(6)
  v_mfma_f32_16x16x32_bf16 a[36:39], a[180:183], a[108:111], a[36:39]
  ds_read_b64_tr_b16 a[156:157], v9 offset:13408
  v_mfma_f32_16x16x32_bf16 v[212:215], a[180:183], a[104:107], v[212:215]
  s_add_u32 m0, s43, 4096
  v_add_u32 v7, s50, v7
  v_mfma_f32_16x16x32_bf16 v[132:135], a[180:183], a[100:103], v[132:135]
  ds_read_b64_tr_b16 a[158:159], v9 offset:16992
  v_mfma_f32_16x16x32_bf16 v[52:55], a[180:183], a[96:99], v[52:55]
  buffer_load_dwordx4 v6, s[28:31], s36 offen lds
  v_add_u32 v8, s50, v8
  s_waitcnt lgkmcnt(6)
  v_mfma_f32_16x16x32_bf16 v[56:59], a[144:147], a[96:99], v[56:59]
  ds_read_b64_tr_b16 a[160:161], v9 offset:6272
  v_mfma_f32_16x16x32_bf16 v[136:139], a[144:147], a[100:103], v[136:139]
  v_mfma_f32_16x16x32_bf16 v[216:219], a[144:147], a[104:107], v[216:219]
  ds_read_b64_tr_b16 a[162:163], v9 offset:9856
  v_mfma_f32_16x16x32_bf16 a[40:43], a[144:147], a[108:111], a[40:43]
  s_waitcnt lgkmcnt(6)
  v_mfma_f32_16x16x32_bf16 a[44:47], a[148:151], a[108:111], a[44:47]
  ds_read_b64_tr_b16 a[164:165], v9 offset:13440
  v_mfma_f32_16x16x32_bf16 v[220:223], a[148:151], a[104:107], v[220:223]
  buffer_load_dwordx4 a[80:83], v1, s[8:11], s42 offen offset:0 sc1
  v_mfma_f32_16x16x32_bf16 v[140:143], a[148:151], a[100:103], v[140:143]
  ds_read_b64_tr_b16 a[166:167], v9 offset:17024
  v_mfma_f32_16x16x32_bf16 v[60:63], a[148:151], a[96:99], v[60:63]
  s_waitcnt lgkmcnt(6)
  v_mfma_f32_16x16x32_bf16 v[64:67], a[152:155], a[96:99], v[64:67]
  ds_read_b64_tr_b16 a[168:169], v9 offset:6304
  v_mfma_f32_16x16x32_bf16 v[144:147], a[152:155], a[100:103], v[144:147]
  v_mfma_f32_16x16x32_bf16 v[224:227], a[152:155], a[104:107], v[224:227]
  ds_read_b64_tr_b16 a[170:171], v9 offset:9888
  v_mfma_f32_16x16x32_bf16 a[48:51], a[152:155], a[108:111], a[48:51]
  s_waitcnt lgkmcnt(6)
  v_mfma_f32_16x16x32_bf16 a[52:55], a[156:159], a[108:111], a[52:55]
  ds_read_b64_tr_b16 a[172:173], v9 offset:13472
  v_mfma_f32_16x16x32_bf16 v[228:231], a[156:159], a[104:107], v[228:231]
  buffer_load_dwordx4 a[84:87], v1, s[8:11], s42 offen offset:1024 sc1
  v_mfma_f32_16x16x32_bf16 v[148:151], a[156:159], a[100:103], v[148:151]
  ds_read_b64_tr_b16 a[174:175], v9 offset:17056
  v_mfma_f32_16x16x32_bf16 v[68:71], a[156:159], a[96:99], v[68:71]
  s_waitcnt lgkmcnt(6)
  v_mfma_f32_16x16x32_bf16 v[72:75], a[160:163], a[96:99], v[72:75]
  ds_read_b64_tr_b16 a[176:177], v9 offset:6336
  v_mfma_f32_16x16x32_bf16 v[152:155], a[160:163], a[100:103], v[152:155]
  v_mfma_f32_16x16x32_bf16 v[232:235], a[160:163], a[104:107], v[232:235]
  ds_read_b64_tr_b16 a[178:179], v9 offset:9920
  v_mfma_f32_16x16x32_bf16 a[56:59], a[160:163], a[108:111], a[56:59]
  s_waitcnt lgkmcnt(6)
  v_mfma_f32_16x16x32_bf16 a[60:63], a[164:167], a[108:111], a[60:63]
  ds_read_b64_tr_b16 a[180:181], v9 offset:13504
  v_mfma_f32_16x16x32_bf16 v[236:239], a[164:167], a[104:107], v[236:239]
  buffer_load_dwordx4 a[88:91], v1, s[8:11], s42 offen offset:2048 sc1
  v_mfma_f32_16x16x32_bf16 v[156:159], a[164:167], a[100:103], v[156:159]
  ds_read_b64_tr_b16 a[182:183], v9 offset:17088
  v_mfma_f32_16x16x32_bf16 v[76:79], a[164:167], a[96:99], v[76:79]
  v_add_u32 v9, s50, v9
  s_waitcnt lgkmcnt(6)
  v_mfma_f32_16x16x32_bf16 v[80:83], a[168:171], a[96:99], v[80:83]
  ds_read_b64_tr_b16 a[144:145], v7 offset:0
  v_mfma_f32_16x16x32_bf16 v[160:163], a[168:171], a[100:103], v[160:163]
  v_mfma_f32_16x16x32_bf16 v[240:243], a[168:171], a[104:107], v[240:243]
  ds_read_b64_tr_b16 a[146:147], v7 offset:3072
  v_mfma_f32_16x16x32_bf16 a[64:67], a[168:171], a[108:111], a[64:67]
  s_waitcnt lgkmcnt(6)
  v_mfma_f32_16x16x32_bf16 a[68:71], a[172:175], a[108:111], a[68:71]
  ds_read_b64_tr_b16 a[148:149], v8 offset:0
  v_mfma_f32_16x16x32_bf16 v[244:247], a[172:175], a[104:107], v[244:247]
  buffer_load_dwordx4 a[92:95], v1, s[8:11], s42 offen offset:3072 sc1
  v_mfma_f32_16x16x32_bf16 v[164:167], a[172:175], a[100:103], v[164:167]
  ds_read_b64_tr_b16 a[150:151], v8 offset:3072
  v_mfma_f32_16x16x32_bf16 v[84:87], a[172:175], a[96:99], v[84:87]
  s_waitcnt lgkmcnt(6)
  v_mfma_f32_16x16x32_bf16 v[88:91], a[176:179], a[96:99], v[88:91]
  ds_read_b64_tr_b16 a[152:153], v7 offset:64
  v_mfma_f32_16x16x32_bf16 v[168:171], a[176:179], a[100:103], v[168:171]
  s_lshl_b32 s42, s73, 12
  s_add_u32 s70, s70, 1
  s_and_b32 s70, s70, 7
  v_mfma_f32_16x16x32_bf16 v[248:251], a[176:179], a[104:107], v[248:251]
  ds_read_b64_tr_b16 a[154:155], v7 offset:3136
  v_mfma_f32_16x16x32_bf16 a[72:75], a[176:179], a[108:111], a[72:75]
  s_cmp_eq_u32 s70, s72
  s_cselect_b32 s51, 8, 0
  s_add_u32 s71, s71, s51
  s_add_u32 s73, s71, s70
  s_waitcnt lgkmcnt(6)
  v_mfma_f32_16x16x32_bf16 a[76:79], a[180:183], a[108:111], a[76:79]
  ds_read_b64_tr_b16 a[156:157], v8 offset:64
  v_mfma_f32_16x16x32_bf16 v[252:255], a[180:183], a[104:107], v[252:255]
  s_cmp_eq_u32 s43, s44
  s_cselect_b32 s51, s66, s67
  s_add_u32 s43, s43, s51
  v_mfma_f32_16x16x32_bf16 v[172:175], a[180:183], a[100:103], v[172:175]
  ds_read_b64_tr_b16 a[158:159], v8 offset:3136
  v_mfma_f32_16x16x32_bf16 v[92:95], a[180:183], a[96:99], v[92:95]
  s_waitcnt vmcnt(18)
  s_barrier
  s_waitcnt lgkmcnt(6)
  v_mfma_f32_16x16x32_bf16 v[16:19], a[144:147], a[112:115], v[16:19]
  ds_read_b64_tr_b16 a[160:161], v7 offset:128
  v_mfma_f32_16x16x32_bf16 v[96:99], a[144:147], a[116:119], v[96:99]
  v_mfma_f32_16x16x32_bf16 v[176:179], a[144:147], a[120:123], v[176:179]
  ds_read_b64_tr_b16 a[162:163], v7 offset:3200
  v_mfma_f32_16x16x32_bf16 a[0:3], a[144:147], a[124:127], a[0:3]
  s_mul_i32 s32, s73, s37
  s_waitcnt lgkmcnt(6)
  v_mfma_f32_16x16x32_bf16 a[4:7], a[148:151], a[124:127], a[4:7]
  ds_read_b64_tr_b16 a[164:165], v8 offset:128
  v_mfma_f32_16x16x32_bf16 v[180:183], a[148:151], a[120:123], v[180:183]
  s_add_u32 m0, s43, 0
  v_mfma_f32_16x16x32_bf16 v[100:103], a[148:151], a[116:119], v[100:103]
  ds_read_b64_tr_b16 a[166:167], v8 offset:3200
  v_mfma_f32_16x16x32_bf16 v[20:23], a[148:151], a[112:115], v[20:23]
  buffer_load_dwordx4 v2, s[12:15], s32 offen lds
  s_waitcnt lgkmcnt(6)
  v_mfma_f32_16x16x32_bf16 v[24:27], a[152:155], a[112:115], v[24:27]
  ds_read_b64_tr_b16 a[168:169], v9 offset:6144
  v_mfma_f32_16x16x32_bf16 v[104:107], a[152:155], a[116:119], v[104:107]
  v_mfma_f32_16x16x32_bf16 v[184:187], a[152:155], a[120:123], v[184:187]
  ds_read_b64_tr_b16 a[170:171], v9 offset:9728
  v_mfma_f32_16x16x32_bf16 a[8:11], a[152:155], a[124:127], a[8:11]
  s_mul_i32 s33, s73, s38
  s_waitcnt lgkmcnt(6)
  v_mfma_f32_16x16x32_bf16 a[12:15], a[156:159], a[124:127], a[12:15]
  ds_read_b64_tr_b16 a[172:173], v9 offset:13312
  v_mfma_f32_16x16x32_bf16 v[188:191], a[156:159], a[120:123], v[188:191]
  s_add_u32 m0, s43, 1024
  v_mfma_f32_16x16x32_bf16 v[108:111], a[156:159], a[116:119], v[108:111]
  ds_read_b64_tr_b16 a[174:175], v9 offset:16896
  v_mfma_f32_16x16x32_bf16 v[28:31], a[156:159], a[112:115], v[28:31]
  buffer_load_dwordx4 v3, s[16:19], s33 offen lds
  s_waitcnt lgkmcnt(6)
  v_mfma_f32_16x16x32_bf16 v[32:35], a[112:115], a[160:163], v[32:35]
  ds_read_b64_tr_b16 a[176:177], v9 offset:6176
  v_mfma_f32_16x16x32_bf16 v[112:115], a[116:119], a[160:163], v[112:115]
  v_mfma_f32_16x16x32_bf16 v[192:195], a[120:123], a[160:163], v[192:195]
  ds_read_b64_tr_b16 a[178:179], v9 offset:9760
  v_mfma_f32_16x16x32_bf16 a[16:19], a[124:127], a[160:163], a[16:19]
  s_mul_i32 s34, s73, s39
  s_waitcnt lgkmcnt(6)
  v_mfma_f32_16x16x32_bf16 a[20:23], a[124:127], a[164:167], a[20:23]
  ds_read_b64_tr_b16 a[180:181], v9 offset:13344
  v_mfma_f32_16x16x32_bf16 v[196:199], a[120:123], a[164:167], v[196:199]
  s_add_u32 m0, s43, 2048
  v_mfma_f32_16x16x32_bf16 v[116:119], a[116:119], a[164:167], v[116:119]
  ds_read_b64_tr_b16 a[182:183], v9 offset:16928
  v_mfma_f32_16x16x32_bf16 v[36:39], a[112:115], a[164:167], v[36:39]
  buffer_load_dwordx4 v4, s[20:23], s34 offen lds
  s_waitcnt lgkmcnt(6)
  v_mfma_f32_16x16x32_bf16 v[40:43], a[168:171], a[112:115], v[40:43]
  ds_read_b64_tr_b16 a[144:145], v9 offset:6208
  v_mfma_f32_16x16x32_bf16 v[120:123], a[168:171], a[116:119], v[120:123]
  v_mfma_f32_16x16x32_bf16 v[200:203], a[168:171], a[120:123], v[200:203]
  ds_read_b64_tr_b16 a[146:147], v9 offset:9792
  v_mfma_f32_16x16x32_bf16 a[24:27], a[168:171], a[124:127], a[24:27]
  s_mul_i32 s35, s73, s40
  s_waitcnt lgkmcnt(6)
  v_mfma_f32_16x16x32_bf16 a[28:31], a[172:175], a[124:127], a[28:31]
  ds_read_b64_tr_b16 a[148:149], v9 offset:13376
  v_mfma_f32_16x16x32_bf16 v[204:207], a[172:175], a[120:123], v[204:207]
  s_add_u32 m0, s43, 3072
  v_mfma_f32_16x16x32_bf16 v[124:127], a[172:175], a[116:119], v[124:127]
  ds_read_b64_tr_b16 a[150:151], v9 offset:16960
  v_mfma_f32_16x16x32_bf16 v[44:47], a[172:175], a[112:115], v[44:47]
  buffer_load_dwordx4 v5, s[24:27], s35 offen lds
  s_cmp_eq_u32 s45, 81920
  s_cselect_b32 s50, s66, s67
  s_waitcnt lgkmcnt(6)
  v_mfma_f32_16x16x32_bf16 v[48:51], a[176:179], a[112:115], v[48:51]
  ds_read_b64_tr_b16 a[152:153], v9 offset:6240
  v_mfma_f32_16x16x32_bf16 v[128:131], a[176:179], a[116:119], v[128:131]
  v_mfma_f32_16x16x32_bf16 v[208:211], a[176:179], a[120:123], v[208:211]
  ds_read_b64_tr_b16 a[154:155], v9 offset:9824
  v_mfma_f32_16x16x32_bf16 a[32:35], a[176:179], a[124:127], a[32:35]
  s_mul_i32 s36, s73, s41
  s_add_u32 s45, s45, s50
  s_waitcnt lgkmcnt(6)
  v_mfma_f32_16x16x32_bf16 a[36:39], a[180:183], a[124:127], a[36:39]
  ds_read_b64_tr_b16 a[156:157], v9 offset:13408
  v_mfma_f32_16x16x32_bf16 v[212:215], a[180:183], a[120:123], v[212:215]
  s_add_u32 m0, s43, 4096
  v_add_u32 v7, s50, v7
  v_mfma_f32_16x16x32_bf16 v[132:135], a[180:183], a[116:119], v[132:135]
  ds_read_b64_tr_b16 a[158:159], v9 offset:16992
  v_mfma_f32_16x16x32_bf16 v[52:55], a[180:183], a[112:115], v[52:55]
  buffer_load_dwordx4 v6, s[28:31], s36 offen lds
  v_add_u32 v8, s50, v8
  s_waitcnt lgkmcnt(6)
  v_mfma_f32_16x16x32_bf16 v[56:59], a[144:147], a[112:115], v[56:59]
  ds_read_b64_tr_b16 a[160:161], v9 offset:6272
  v_mfma_f32_16x16x32_bf16 v[136:139], a[144:147], a[116:119], v[136:139]
  v_mfma_f32_16x16x32_bf16 v[216:219], a[144:147], a[120:123], v[216:219]
  ds_read_b64_tr_b16 a[162:163], v9 offset:9856
  v_mfma_f32_16x16x32_bf16 a[40:43], a[144:147], a[124:127], a[40:43]
  s_waitcnt lgkmcnt(6)
  v_mfma_f32_16x16x32_bf16 a[44:47], a[148:151], a[124:127], a[44:47]
  ds_read_b64_tr_b16 a[164:165], v9 offset:13440
  v_mfma_f32_16x16x32_bf16 v[220:223], a[148:151], a[120:123], v[220:223]
  buffer_load_dwordx4 a[96:99], v1, s[8:11], s42 offen offset:0 sc1
  v_mfma_f32_16x16x32_bf16 v[140:143], a[148:151], a[116:119], v[140:143]
  ds_read_b64_tr_b16 a[166:167], v9 offset:17024
  v_mfma_f32_16x16x32_bf16 v[60:63], a[148:151], a[112:115], v[60:63]
  s_waitcnt lgkmcnt(6)
  v_mfma_f32_16x16x32_bf16 v[64:67], a[152:155], a[112:115], v[64:67]
  ds_read_b64_tr_b16 a[168:169], v9 offset:6304
  v_mfma_f32_16x16x32_bf16 v[144:147], a[152:155], a[116:119], v[144:147]
  v_mfma_f32_16x16x32_bf16 v[224:227], a[152:155], a[120:123], v[224:227]
  ds_read_b64_tr_b16 a[170:171], v9 offset:9888
  v_mfma_f32_16x16x32_bf16 a[48:51], a[152:155], a[124:127], a[48:51]
  s_waitcnt lgkmcnt(6)
  v_mfma_f32_16x16x32_bf16 a[52:55], a[156:159], a[124:127], a[52:55]
  ds_read_b64_tr_b16 a[172:173], v9 offset:13472
  v_mfma_f32_16x16x32_bf16 v[228:231], a[156:159], a[120:123], v[228:231]
  buffer_load_dwordx4 a[100:103], v1, s[8:11], s42 offen offset:1024 sc1
  v_mfma_f32_16x16x32_bf16 v[148:151], a[156:159], a[116:119], v[148:151]
  ds_read_b64_tr_b16 a[174:175], v9 offset:17056
  v_mfma_f32_16x16x32_bf16 v[68:71], a[156:159], a[112:115], v[68:71]
  s_waitcnt lgkmcnt(6)
  v_mfma_f32_16x16x32_bf16 v[72:75], a[160:163], a[112:115], v[72:75]
  ds_read_b64_tr_b16 a[176:177], v9 offset:6336
  v_mfma_f32_16x16x32_bf16 v[152:155], a[160:163], a[116:119], v[152:155]
  v_mfma_f32_16x16x32_bf16 v[232:235], a[160:163], a[120:123], v[232:235]
  ds_read_b64_tr_b16 a[178:179], v9 offset:9920
  v_mfma_f32_16x16x32_bf16 a[56:59], a[160:163], a[124:127], a[56:59]
  s_waitcnt lgkmcnt(6)
  v_mfma_f32_16x16x32_bf16 a[60:63], a[164:167], a[124:127], a[60:63]
  ds_read_b64_tr_b16 a[180:181], v9 offset:13504
  v_mfma_f32_16x16x32_bf16 v[236:239], a[164:167], a[120:123], v[236:239]
  buffer_load_dwordx4 a[104:107], v1, s[8:11], s42 offen offset:2048 sc1
  v_mfma_f32_16x16x32_bf16 v[156:159], a[164:167], a[116:119], v[156:159]
  ds_read_b64_tr_b16 a[182:183], v9 offset:17088
  v_mfma_f32_16x16x32_bf16 v[76:79], a[164:167], a[112:115], v[76:79]
  v_add_u32 v9, s50, v9
  s_waitcnt lgkmcnt(6)
  v_mfma_f32_16x16x32_bf16 v[80:83], a[168:171], a[112:115], v[80:83]
  ds_read_b64_tr_b16 a[144:145], v7 offset:0
  v_mfma_f32_16x16x32_bf16 v[160:163], a[168:171], a[116:119], v[160:163]
  v_mfma_f32_16x16x32_bf16 v[240:243], a[168:171], a[120:123], v[240:243]
  ds_read_b64_tr_b16 a[146:147], v7 offset:3072
  v_mfma_f32_16x16x32_bf16 a[64:67], a[168:171], a[124:127], a[64:67]
  s_waitcnt lgkmcnt(6)
  v_mfma_f32_16x16x32_bf16 a[68:71], a[172:175], a[124:127], a[68:71]
  ds_read_b64_tr_b16 a[148:149], v8 offset:0
  v_mfma_f32_16x16x32_bf16 v[244:247], a[172:175], a[120:123], v[244:247]
  buffer_load_dwordx4 a[108:111], v1, s[8:11], s42 offen offset:3072 sc1
  v_mfma_f32_16x16x32_bf16 v[164:167], a[172:175], a[116:119], v[164:167]
  ds_read_b64_tr_b16 a[150:151], v8 offset:3072
  v_mfma_f32_16x16x32_bf16 v[84:87], a[172:175], a[112:115], v[84:87]
  s_waitcnt lgkmcnt(6)
  v_mfma_f32_16x16x32_bf16 v[88:91], a[176:179], a[112:115], v[88:91]
  ds_read_b64_tr_b16 a[152:153], v7 offset:64
  v_mfma_f32_16x16x32_bf16 v[168:171], a[176:179], a[116:119], v[168:171]
  s_lshl_b32 s42, s73, 12
  s_add_u32 s70, s70, 1
  s_and_b32 s70, s70, 7
  v_mfma_f32_16x16x32_bf16 v[248:251], a[176:179], a[120:123], v[248:251]
  ds_read_b64_tr_b16 a[154:155], v7 offset:3136
  v_mfma_f32_16x16x32_bf16 a[72:75], a[176:179], a[124:127], a[72:75]
  s_cmp_eq_u32 s70, s72
  s_cselect_b32 s51, 8, 0
  s_add_u32 s71, s71, s51
  s_add_u32 s73, s71, s70
  s_waitcnt lgkmcnt(6)
  v_mfma_f32_16x16x32_bf16 a[76:79], a[180:183], a[124:127], a[76:79]
  ds_read_b64_tr_b16 a[156:157], v8 offset:64
  v_mfma_f32_16x16x32_bf16 v[252:255], a[180:183], a[120:123], v[252:255]
  s_cmp_eq_u32 s43, s44
  s_cselect_b32 s51, s66, s67
  s_add_u32 s43, s43, s51
  v_mfma_f32_16x16x32_bf16 v[172:175], a[180:183], a[116:119], v[172:175]
  ds_read_b64_tr_b16 a[158:159], v8 offset:3136
  v_mfma_f32_16x16x32_bf16 v[92:95], a[180:183], a[112:115], v[92:95]
  s_waitcnt vmcnt(18)
  s_barrier
  s_waitcnt lgkmcnt(6)
  v_mfma_f32_16x16x32_bf16 v[16:19], a[144:147], a[128:131], v[16:19]
  ds_read_b64_tr_b16 a[160:161], v7 offset:128
  v_mfma_f32_16x16x32_bf16 v[96:99], a[144:147], a[132:135], v[96:99]
  v_mfma_f32_16x16x32_bf16 v[176:179], a[144:147], a[136:139], v[176:179]
  ds_read_b64_tr_b16 a[162:163], v7 offset:3200
  v_mfma_f32_16x16x32_bf16 a[0:3], a[144:147], a[140:143], a[0:3]
  s_mul_i32 s32, s73, s37
  s_waitcnt lgkmcnt(6)
  v_mfma_f32_16x16x32_bf16 a[4:7], a[148:151], a[140:143], a[4:7]
  ds_read_b64_tr_b16 a[164:165], v8 offset:128
  v_mfma_f32_16x16x32_bf16 v[180:183], a[148:151], a[136:139], v[180:183]
  s_add_u32 m0, s43, 0
  v_mfma_f32_16x16x32_bf16 v[100:103], a[148:151], a[132:135], v[100:103]
  ds_read_b64_tr_b16 a[166:167], v8 offset:3200
  v_mfma_f32_16x16x32_bf16 v[20:23], a[148:151], a[128:131], v[20:23]
  buffer_load_dwordx4 v2, s[12:15], s32 offen lds
  s_waitcnt lgkmcnt(6)
  v_mfma_f32_16x16x32_bf16 v[24:27], a[152:155], a[128:131], v[24:27]
  ds_read_b64_tr_b16 a[168:169], v9 offset:6144
  v_mfma_f32_16x16x32_bf16 v[104:107], a[152:155], a[132:135], v[104:107]
  v_mfma_f32_16x16x32_bf16 v[184:187], a[152:155], a[136:139], v[184:187]
  ds_read_b64_tr_b16 a[170:171], v9 offset:9728
  v_mfma_f32_16x16x32_bf16 a[8:11], a[152:155], a[140:143], a[8:11]
  s_mul_i32 s33, s73, s38
  s_waitcnt lgkmcnt(6)
  v_mfma_f32_16x16x32_bf16 a[12:15], a[156:159], a[140:143], a[12:15]
  ds_read_b64_tr_b16 a[172:173], v9 offset:13312
  v_mfma_f32_16x16x32_bf16 v[188:191], a[156:159], a[136:139], v[188:191]
  s_add_u32 m0, s43, 1024
  v_mfma_f32_16x16x32_bf16 v[108:111], a[156:159], a[132:135], v[108:111]
  ds_read_b64_tr_b16 a[174:175], v9 offset:16896
  v_mfma_f32_16x16x32_bf16 v[28:31], a[156:159], a[128:131], v[28:31]
  buffer_load_dwordx4 v3, s[16:19], s33 offen lds
  s_waitcnt lgkmcnt(6)
  v_mfma_f32_16x16x32_bf16 v[32:35], a[128:131], a[160:163], v[32:35]
  ds_read_b64_tr_b16 a[176:177], v9 offset:6176
  v_mfma_f32_16x16x32_bf16 v[112:115], a[132:135], a[160:163], v[112:115]
  v_mfma_f32_16x16x32_bf16 v[192:195], a[136:139], a[160:163], v[192:195]
  ds_read_b64_tr_b16 a[178:179], v9 offset:9760
  v_mfma_f32_16x16x32_bf16 a[16:19], a[140:143], a[160:163], a[16:19]
  s_mul_i32 s34, s73, s39
  s_waitcnt lgkmcnt(6)
  v_mfma_f32_16x16x32_bf16 a[20:23], a[140:143], a[164:167], a[20:23]
  ds_read_b64_tr_b16 a[180:181], v9 offset:13344
  v_mfma_f32_16x16x32_bf16 v[196:199], a[136:139], a[164:167], v[196:199]
  s_add_u32 m0, s43, 2048
  v_mfma_f32_16x16x32_bf16 v[116:119], a[132:135], a[164:167], v[116:119]
  ds_read_b64_tr_b16 a[182:183], v9 offset:16928
  v_mfma_f32_16x16x32_bf16 v[36:39], a[128:131], a[164:167], v[36:39]
  buffer_load_dwordx4 v4, s[20:23], s34 offen lds
  s_waitcnt lgkmcnt(6)
  v_mfma_f32_16x16x32_bf16 v[40:43], a[168:171], a[128:131], v[40:43]
  ds_read_b64_tr_b16 a[144:145], v9 offset:6208
  v_mfma_f32_16x16x32_bf16 v[120:123], a[168:171], a[132:135], v[120:123]
  v_mfma_f32_16x16x32_bf16 v[200:203], a[168:171], a[136:139], v[200:203]
  ds_read_b64_tr_b16 a[146:147], v9 offset:9792
  v_mfma_f32_16x16x32_bf16 a[24:27], a[168:171], a[140:143], a[24:27]
  s_mul_i32 s35, s73, s40
  s_waitcnt lgkmcnt(6)
  v_mfma_f32_16x16x32_bf16 a[28:31], a[172:175], a[140:143], a[28:31]
  ds_read_b64_tr_b16 a[148:149], v9 offset:13376
  v_mfma_f32_16x16x32_bf16 v[204:207], a[172:175], a[136:139], v[204:207]
  s_add_u32 m0, s43, 3072
  v_mfma_f32_16x16x32_bf16 v[124:127], a[172:175], a[132:135], v[124:127]
  ds_read_b64_tr_b16 a[150:151], v9 offset:16960
  v_mfma_f32_16x16x32_bf16 v[44:47], a[172:175], a[128:131], v[44:47]
  buffer_load_dwordx4 v5, s[24:27], s35 offen lds
  s_cmp_eq_u32 s45, 81920
  s_cselect_b32 s50, s66, s67
  s_waitcnt lgkmcnt(6)
  v_mfma_f32_16x16x32_bf16 v[48:51], a[176:179], a[128:131], v[48:51]
  ds_read_b64_tr_b16 a[152:153], v9 offset:6240
  v_mfma_f32_16x16x32_bf16 v[128:131], a[176:179], a[132:135], v[128:131]
  v_mfma_f32_16x16x32_bf16 v[208:211], a[176:179], a[136:139], v[208:211]
  ds_read_b64_tr_b16 a[154:155], v9 offset:9824
  v_mfma_f32_16x16x32_bf16 a[32:35], a[176:179], a[140:143], a[32:35]
  s_mul_i32 s36, s73, s41
  s_add_u32 s45, s45, s50
  s_waitcnt lgkmcnt(6)
  v_mfma_f32_16x16x32_bf16 a[36:39], a[180:183], a[140:143], a[36:39]
  ds_read_b64_tr_b16 a[156:157], v9 offset:13408
  v_mfma_f32_16x16x32_bf16 v[212:215], a[180:183], a[136:139], v[212:215]
  s_add_u32 m0, s43, 4096
  v_add_u32 v7, s50, v7
  v_mfma_f32_16x16x32_bf16 v[132:135], a[180:183], a[132:135], v[132:135]
  ds_read_b64_tr_b16 a[158:159], v9 offset:16992
  v_mfma_f32_16x16x32_bf16 v[52:55], a[180:183], a[128:131], v[52:55]
  buffer_load_dwordx4 v6, s[28:31], s36 offen lds
  v_add_u32 v8, s50, v8
  s_waitcnt lgkmcnt(6)
  v_mfma_f32_16x16x32_bf16 v[56:59], a[144:147], a[128:131], v[56:59]
  ds_read_b64_tr_b16 a[160:161], v9 offset:6272
  v_mfma_f32_16x16x32_bf16 v[136:139], a[144:147], a[132:135], v[136:139]
  v_mfma_f32_16x16x32_bf16 v[216:219], a[144:147], a[136:139], v[216:219]
  ds_read_b64_tr_b16 a[162:163], v9 offset:9856
  v_mfma_f32_16x16x32_bf16 a[40:43], a[144:147], a[140:143], a[40:43]
  s_waitcnt lgkmcnt(6)
  v_mfma_f32_16x16x32_bf16 a[44:47], a[148:151], a[140:143], a[44:47]
  ds_read_b64_tr_b16 a[164:165], v9 offset:13440
  v_mfma_f32_16x16x32_bf16 v[220:223], a[148:151], a[136:139], v[220:223]
  buffer_load_dwordx4 a[112:115], v1, s[8:11], s42 offen offset:0 sc1
  v_mfma_f32_16x16x32_bf16 v[140:143], a[148:151], a[132:135], v[140:143]
  ds_read_b64_tr_b16 a[166:167], v9 offset:17024
  v_mfma_f32_16x16x32_bf16 v[60:63], a[148:151], a[128:131], v[60:63]
  s_waitcnt lgkmcnt(6)
  v_mfma_f32_16x16x32_bf16 v[64:67], a[152:155], a[128:131], v[64:67]
  ds_read_b64_tr_b16 a[168:169], v9 offset:6304
  v_mfma_f32_16x16x32_bf16 v[144:147], a[152:155], a[132:135], v[144:147]
  v_mfma_f32_16x16x32_bf16 v[224:227], a[152:155], a[136:139], v[224:227]
  ds_read_b64_tr_b16 a[170:171], v9 offset:9888
  v_mfma_f32_16x16x32_bf16 a[48:51], a[152:155], a[140:143], a[48:51]
  s_waitcnt lgkmcnt(6)
  v_mfma_f32_16x16x32_bf16 a[52:55], a[156:159], a[140:143], a[52:55]
  ds_read_b64_tr_b16 a[172:173], v9 offset:13472
  v_mfma_f32_16x16x32_bf16 v[228:231], a[156:159], a[136:139], v[228:231]
  buffer_load_dwordx4 a[116:119], v1, s[8:11], s42 offen offset:1024 sc1
  v_mfma_f32_16x16x32_bf16 v[148:151], a[156:159], a[132:135], v[148:151]
  ds_read_b64_tr_b16 a[174:175], v9 offset:17056
  v_mfma_f32_16x16x32_bf16 v[68:71], a[156:159], a[128:131], v[68:71]
  s_waitcnt lgkmcnt(6)
  v_mfma_f32_16x16x32_bf16 v[72:75], a[160:163], a[128:131], v[72:75]
  ds_read_b64_tr_b16 a[176:177], v9 offset:6336
  v_mfma_f32_16x16x32_bf16 v[152:155], a[160:163], a[132:135], v[152:155]
  v_mfma_f32_16x16x32_bf16 v[232:235], a[160:163], a[136:139], v[232:235]
  ds_read_b64_tr_b16 a[178:179], v9 offset:9920
  v_mfma_f32_16x16x32_bf16 a[56:59], a[160:163], a[140:143], a[56:59]
  s_waitcnt lgkmcnt(6)
  v_mfma_f32_16x16x32_bf16 a[60:63], a[164:167], a[140:143], a[60:63]
  ds_read_b64_tr_b16 a[180:181], v9 offset:13504
  v_mfma_f32_16x16x32_bf16 v[236:239], a[164:167], a[136:139], v[236:239]
  buffer_load_dwordx4 a[120:123], v1, s[8:11], s42 offen offset:2048 sc1
  v_mfma_f32_16x16x32_bf16 v[156:159], a[164:167], a[132:135], v[156:159]
  ds_read_b64_tr_b16 a[182:183], v9 offset:17088
  v_mfma_f32_16x16x32_bf16 v[76:79], a[164:167], a[128:131], v[76:79]
  v_add_u32 v9, s50, v9
  s_waitcnt lgkmcnt(6)
  v_mfma_f32_16x16x32_bf16 v[80:83], a[168:171], a[128:131], v[80:83]
  ds_read_b64_tr_b16 a[144:145], v7 offset:0
  v_mfma_f32_16x16x32_bf16 v[160:163], a[168:171], a[132:135], v[160:163]
  v_mfma_f32_16x16x32_bf16 v[240:243], a[168:171], a[136:139], v[240:243]
  ds_read_b64_tr_b16 a[146:147], v7 offset:3072
  v_mfma_f32_16x16x32_bf16 a[64:67], a[168:171], a[140:143], a[64:67]
  s_waitcnt lgkmcnt(6)
  v_mfma_f32_16x16x32_bf16 a[68:71], a[172:175], a[140:143], a[68:71]
  ds_read_b64_tr_b16 a[148:149], v8 offset:0
  v_mfma_f32_16x16x32_bf16 v[244:247], a[172:175], a[136:139], v[244:247]
  buffer_load_dwordx4 a[124:127], v1, s[8:11], s42 offen offset:3072 sc1
  v_mfma_f32_16x16x32_bf16 v[164:167], a[172:175], a[132:135], v[164:167]
  ds_read_b64_tr_b16 a[150:151], v8 offset:3072
  v_mfma_f32_16x16x32_bf16 v[84:87], a[172:175], a[128:131], v[84:87]
  s_waitcnt lgkmcnt(6)
  v_mfma_f32_16x16x32_bf16 v[88:91], a[176:179], a[128:131], v[88:91]
  ds_read_b64_tr_b16 a[152:153], v7 offset:64
  v_mfma_f32_16x16x32_bf16 v[168:171], a[176:179], a[132:135], v[168:171]
  s_lshl_b32 s42, s73, 12
  s_add_u32 s70, s70, 1
  s_and_b32 s70, s70, 7
  v_mfma_f32_16x16x32_bf16 v[248:251], a[176:179], a[136:139], v[248:251]
  ds_read_b64_tr_b16 a[154:155], v7 offset:3136
  v_mfma_f32_16x16x32_bf16 a[72:75], a[176:179], a[140:143], a[72:75]
  s_cmp_eq_u32 s70, s72
  s_cselect_b32 s51, 8, 0
  s_add_u32 s71, s71, s51
  s_add_u32 s73, s71, s70
  s_waitcnt lgkmcnt(6)
  v_mfma_f32_16x16x32_bf16 a[76:79], a[180:183], a[140:143], a[76:79]
  ds_read_b64_tr_b16 a[156:157], v8 offset:64
  v_mfma_f32_16x16x32_bf16 v[252:255], a[180:183], a[136:139], v[252:255]
  s_cmp_eq_u32 s43, s44
  s_cselect_b32 s51, s66, s67
  s_add_u32 s43, s43, s51
  v_mfma_f32_16x16x32_bf16 v[172:175], a[180:183], a[132:135], v[172:175]
  ds_read_b64_tr_b16 a[158:159], v8 offset:3136
  v_mfma_f32_16x16x32_bf16 v[92:95], a[180:183], a[128:131], v[92:95]
  s_add_u32 s46, s46, 1
  s_cmp_lt_u32 s46, 7
  s_cbranch_scc1 L_k2_loop
  s_waitcnt vmcnt(18)
  s_barrier
  s_waitcnt lgkmcnt(6)
  v_mfma_f32_16x16x32_bf16 v[16:19], a[144:147], a[80:83], v[16:19]
  ds_read_b64_tr_b16 a[160:161], v7 offset:128
  v_mfma_f32_16x16x32_bf16 v[96:99], a[144:147], a[84:87], v[96:99]
  v_mfma_f32_16x16x32_bf16 v[176:179], a[144:147], a[88:91], v[176:179]
  ds_read_b64_tr_b16 a[162:163], v7 offset:3200
  v_mfma_f32_16x16x32_bf16 a[0:3], a[144:147], a[92:95], a[0:3]
  s_waitcnt lgkmcnt(6)
  v_mfma_f32_16x16x32_bf16 a[4:7], a[148:151], a[92:95], a[4:7]
  ds_read_b64_tr_b16 a[164:165], v8 offset:128
  v_mfma_f32_16x16x32_bf16 v[180:183], a[148:151], a[88:91], v[180:183]
  v_mfma_f32_16x16x32_bf16 v[100:103], a[148:151], a[84:87], v[100:103]
  ds_read_b64_tr_b16 a[166:167], v8 offset:3200
  v_mfma_f32_16x16x32_bf16 v[20:23], a[148:151], a[80:83], v[20:23]
  s_waitcnt lgkmcnt(6)
  v_mfma_f32_16x16x32_bf16 v[24:27], a[152:155], a[80:83], v[24:27]
  ds_read_b64_tr_b16 a[168:169], v9 offset:6144
  v_mfma_f32_16x16x32_bf16 v[104:107], a[152:155], a[84:87], v[104:107]
  buffer_load_dwordx4 a[128:131], v1, s[8:11], s42 offen offset:0 sc1
  v_mfma_f32_16x16x32_bf16 v[184:187], a[152:155], a[88:91], v[184:187]
  ds_read_b64_tr_b16 a[170:171], v9 offset:9728
  v_mfma_f32_16x16x32_bf16 a[8:11], a[152:155], a[92:95], a[8:11]
  s_waitcnt lgkmcnt(6)
  v_mfma_f32_16x16x32_bf16 a[12:15], a[156:159], a[92:95], a[12:15]
  ds_read_b64_tr_b16 a[172:173], v9 offset:13312
  v_mfma_f32_16x16x32_bf16 v[188:191], a[156:159], a[88:91], v[188:191]
  v_mfma_f32_16x16x32_bf16 v[108:111], a[156:159], a[84:87], v[108:111]
  ds_read_b64_tr_b16 a[174:175], v9 offset:16896
  v_mfma_f32_16x16x32_bf16 v[28:31], a[156:159], a[80:83], v[28:31]
  s_waitcnt lgkmcnt(6)
  v_mfma_f32_16x16x32_bf16 v[32:35], a[80:83], a[160:163], v[32:35]
  ds_read_b64_tr_b16 a[176:177], v9 offset:6176
  v_mfma_f32_16x16x32_bf16 v[112:115], a[84:87], a[160:163], v[112:115]
  buffer_load_dwordx4 a[132:135], v1, s[8:11], s42 offen offset:1024 sc1
  v_mfma_f32_16x16x32_bf16 v[192:195], a[88:91], a[160:163], v[192:195]
  ds_read_b64_tr_b16 a[178:179], v9 offset:9760
  v_mfma_f32_16x16x32_bf16 a[16:19], a[92:95], a[160:163], a[16:19]
  s_waitcnt lgkmcnt(6)
  v_mfma_f32_16x16x32_bf16 a[20:23], a[92:95], a[164:167], a[20:23]
  ds_read_b64_tr_b16 a[180:181], v9 offset:13344
  v_mfma_f32_16x16x32_bf16 v[196:199], a[88:91], a[164:167], v[196:199]
  v_mfma_f32_16x16x32_bf16 v[116:119], a[84:87], a[164:167], v[116:119]
  ds_read_b64_tr_b16 a[182:183], v9 offset:16928
  v_mfma_f32_16x16x32_bf16 v[36:39], a[80:83], a[164:167], v[36:39]
  s_waitcnt lgkmcnt(6)
  v_mfma_f32_16x16x32_bf16 v[40:43], a[168:171], a[80:83], v[40:43]
  ds_read_b64_tr_b16 a[144:145], v9 offset:6208
  v_mfma_f32_16x16x32_bf16 v[120:123], a[168:171], a[84:87], v[120:123]
  buffer_load_dwordx4 a[136:139], v1, s[8:11], s42 offen offset:2048 sc1
  v_mfma_f32_16x16x32_bf16 v[200:203], a[168:171], a[88:91], v[200:203]
  ds_read_b64_tr_b16 a[146:147], v9 offset:9792
  v_mfma_f32_16x16x32_bf16 a[24:27], a[168:171], a[92:95], a[24:27]
  s_waitcnt lgkmcnt(6)
  v_mfma_f32_16x16x32_bf16 a[28:31], a[172:175], a[92:95], a[28:31]
  ds_read_b64_tr_b16 a[148:149], v9 offset:13376
  v_mfma_f32_16x16x32_bf16 v[204:207], a[172:175], a[88:91], v[204:207]
  v_mfma_f32_16x16x32_bf16 v[124:127], a[172:175], a[84:87], v[124:127]
  ds_read_b64_tr_b16 a[150:151], v9 offset:16960
  v_mfma_f32_16x16x32_bf16 v[44:47], a[172:175], a[80:83], v[44:47]
  s_cmp_eq_u32 s45, 81920
  s_cselect_b32 s50, s66, s67
  s_waitcnt lgkmcnt(6)
  v_mfma_f32_16x16x32_bf16 v[48:51], a[176:179], a[80:83], v[48:51]
  ds_read_b64_tr_b16 a[152:153], v9 offset:6240
  v_mfma_f32_16x16x32_bf16 v[128:131], a[176:179], a[84:87], v[128:131]
  buffer_load_dwordx4 a[140:143], v1, s[8:11], s42 offen offset:3072 sc1
  v_mfma_f32_16x16x32_bf16 v[208:211], a[176:179], a[88:91], v[208:211]
  ds_read_b64_tr_b16 a[154:155], v9 offset:9824
  v_mfma_f32_16x16x32_bf16 a[32:35], a[176:179], a[92:95], a[32:35]
  s_add_u32 s45, s45, s50
  s_waitcnt lgkmcnt(6)
  v_mfma_f32_16x16x32_bf16 a[36:39], a[180:183], a[92:95], a[36:39]
  ds_read_b64_tr_b16 a[156:157], v9 offset:13408
  v_mfma_f32_16x16x32_bf16 v[212:215], a[180:183], a[88:91], v[212:215]
  v_add_u32 v7, s50, v7
  v_mfma_f32_16x16x32_bf16 v[132:135], a[180:183], a[84:87], v[132:135]
  ds_read_b64_tr_b16 a[158:159], v9 offset:16992
  v_mfma_f32_16x16x32_bf16 v[52:55], a[180:183], a[80:83], v[52:55]
  v_add_u32 v8, s50, v8
  s_waitcnt lgkmcnt(6)
  v_mfma_f32_16x16x32_bf16 v[56:59], a[144:147], a[80:83], v[56:59]
  ds_read_b64_tr_b16 a[160:161], v9 offset:6272
  v_mfma_f32_16x16x32_bf16 v[136:139], a[144:147], a[84:87], v[136:139]
  v_mfma_f32_16x16x32_bf16 v[216:219], a[144:147], a[88:91], v[216:219]
  ds_read_b64_tr_b16 a[162:163], v9 offset:9856
  v_mfma_f32_16x16x32_bf16 a[40:43], a[144:147], a[92:95], a[40:43]
  s_waitcnt lgkmcnt(6)
  v_mfma_f32_16x16x32_bf16 a[44:47], a[148:151], a[92:95], a[44:47]
  ds_read_b64_tr_b16 a[164:165], v9 offset:13440
  v_mfma_f32_16x16x32_bf16 v[220:223], a[148:151], a[88:91], v[220:223]
  buffer_load_dword a252, v10, s[76:79], s74 offen
  v_mfma_f32_16x16x32_bf16 v[140:143], a[148:151], a[84:87], v[140:143]
  ds_read_b64_tr_b16 a[166:167], v9 offset:17024
  v_mfma_f32_16x16x32_bf16 v[60:63], a[148:151], a[80:83], v[60:63]
  s_waitcnt lgkmcnt(6)
  v_mfma_f32_16x16x32_bf16 v[64:67], a[152:155], a[80:83], v[64:67]
  ds_read_b64_tr_b16 a[168:169], v9 offset:6304
  v_mfma_f32_16x16x32_bf16 v[144:147], a[152:155], a[84:87], v[144:147]
  v_mfma_f32_16x16x32_bf16 v[224:227], a[152:155], a[88:91], v[224:227]
  ds_read_b64_tr_b16 a[170:171], v9 offset:9888
  v_mfma_f32_16x16x32_bf16 a[48:51], a[152:155], a[92:95], a[48:51]
  s_waitcnt lgkmcnt(6)
  v_mfma_f32_16x16x32_bf16 a[52:55], a[156:159], a[92:95], a[52:55]
  ds_read_b64_tr_b16 a[172:173], v9 offset:13472
  v_mfma_f32_16x16x32_bf16 v[228:231], a[156:159], a[88:91], v[228:231]
  buffer_load_dword a253, v11, s[80:83], s75 offen
  v_mfma_f32_16x16x32_bf16 v[148:151], a[156:159], a[84:87], v[148:151]
  ds_read_b64_tr_b16 a[174:175], v9 offset:17056
  v_mfma_f32_16x16x32_bf16 v[68:71], a[156:159], a[80:83], v[68:71]
  s_waitcnt lgkmcnt(6)
  v_mfma_f32_16x16x32_bf16 v[72:75], a[160:163], a[80:83], v[72:75]
  ds_read_b64_tr_b16 a[176:177], v9 offset:6336
  v_mfma_f32_16x16x32_bf16 v[152:155], a[160:163], a[84:87], v[152:155]
  v_mfma_f32_16x16x32_bf16 v[232:235], a[160:163], a[88:91], v[232:235]
  ds_read_b64_tr_b16 a[178:179], v9 offset:9920
  v_mfma_f32_16x16x32_bf16 a[56:59], a[160:163], a[92:95], a[56:59]
  s_waitcnt lgkmcnt(6)
  v_mfma_f32_16x16x32_bf16 a[60:63], a[164:167], a[92:95], a[60:63]
  ds_read_b64_tr_b16 a[180:181], v9 offset:13504
  v_mfma_f32_16x16x32_bf16 v[236:239], a[164:167], a[88:91], v[236:239]
  v_mfma_f32_16x16x32_bf16 v[156:159], a[164:167], a[84:87], v[156:159]
  ds_read_b64_tr_b16 a[182:183], v9 offset:17088
  v_mfma_f32_16x16x32_bf16 v[76:79], a[164:167], a[80:83], v[76:79]
  v_add_u32 v9, s50, v9
  s_waitcnt lgkmcnt(6)
  v_mfma_f32_16x16x32_bf16 v[80:83], a[168:171], a[80:83], v[80:83]
  ds_read_b64_tr_b16 a[144:145], v7 offset:0
  v_mfma_f32_16x16x32_bf16 v[160:163], a[168:171], a[84:87], v[160:163]
  v_mfma_f32_16x16x32_bf16 v[240:243], a[168:171], a[88:91], v[240:243]
  ds_read_b64_tr_b16 a[146:147], v7 offset:3072
  v_mfma_f32_16x16x32_bf16 a[64:67], a[168:171], a[92:95], a[64:67]
  s_waitcnt lgkmcnt(6)
  v_mfma_f32_16x16x32_bf16 a[68:71], a[172:175], a[92:95], a[68:71]
  ds_read_b64_tr_b16 a[148:149], v8 offset:0
  v_mfma_f32_16x16x32_bf16 v[244:247], a[172:175], a[88:91], v[244:247]
  v_mfma_f32_16x16x32_bf16 v[164:167], a[172:175], a[84:87], v[164:167]
  ds_read_b64_tr_b16 a[150:151], v8 offset:3072
  v_mfma_f32_16x16x32_bf16 v[84:87], a[172:175], a[80:83], v[84:87]
  s_waitcnt lgkmcnt(6)
  v_mfma_f32_16x16x32_bf16 v[88:91], a[176:179], a[80:83], v[88:91]
  ds_read_b64_tr_b16 a[152:153], v7 offset:64
  v_mfma_f32_16x16x32_bf16 v[168:171], a[176:179], a[84:87], v[168:171]
  v_mfma_f32_16x16x32_bf16 v[248:251], a[176:179], a[88:91], v[248:251]
  ds_read_b64_tr_b16 a[154:155], v7 offset:3136
  v_mfma_f32_16x16x32_bf16 a[72:75], a[176:179], a[92:95], a[72:75]
  s_waitcnt lgkmcnt(6)
  v_mfma_f32_16x16x32_bf16 a[76:79], a[180:183], a[92:95], a[76:79]
  ds_read_b64_tr_b16 a[156:157], v8 offset:64
  v_mfma_f32_16x16x32_bf16 v[252:255], a[180:183], a[88:91], v[252:255]
  v_mfma_f32_16x16x32_bf16 v[172:175], a[180:183], a[84:87], v[172:175]
  ds_read_b64_tr_b16 a[158:159], v8 offset:3136
  v_mfma_f32_16x16x32_bf16 v[92:95], a[180:183], a[80:83], v[92:95]
  s_waitcnt vmcnt(15)
  s_barrier
  s_waitcnt lgkmcnt(6)
  v_mfma_f32_16x16x32_bf16 v[16:19], a[144:147], a[96:99], v[16:19]
  ds_read_b64_tr_b16 a[160:161], v7 offset:128
  v_mfma_f32_16x16x32_bf16 v[96:99], a[144:147], a[100:103], v[96:99]
  v_mfma_f32_16x16x32_bf16 v[176:179], a[144:147], a[104:107], v[176:179]
  ds_read_b64_tr_b16 a[162:163], v7 offset:3200
  v_mfma_f32_16x16x32_bf16 a[0:3], a[144:147], a[108:111], a[0:3]
  s_waitcnt lgkmcnt(6)
  v_mfma_f32_16x16x32_bf16 a[4:7], a[148:151], a[108:111], a[4:7]
  ds_read_b64_tr_b16 a[164:165], v8 offset:128
  v_mfma_f32_16x16x32_bf16 v[180:183], a[148:151], a[104:107], v[180:183]
  v_mfma_f32_16x16x32_bf16 v[100:103], a[148:151], a[100:103], v[100:103]
  ds_read_b64_tr_b16 a[166:167], v8 offset:3200
  v_mfma_f32_16x16x32_bf16 v[20:23], a[148:151], a[96:99], v[20:23]
  s_waitcnt lgkmcnt(6)
  v_mfma_f32_16x16x32_bf16 v[24:27], a[152:155], a[96:99], v[24:27]
  ds_read_b64_tr_b16 a[168:169], v9 offset:6144
  v_mfma_f32_16x16x32_bf16 v[104:107], a[152:155], a[100:103], v[104:107]
  buffer_store_dwordx4 v[12:15], v1, s[84:87], s88 offen offset:0 sc1
  v_mfma_f32_16x16x32_bf16 v[184:187], a[152:155], a[104:107], v[184:187]
  ds_read_b64_tr_b16 a[170:171], v9 offset:9728
  v_mfma_f32_16x16x32_bf16 a[8:11], a[152:155], a[108:111], a[8:11]
  s_waitcnt lgkmcnt(6)
  v_mfma_f32_16x16x32_bf16 a[12:15], a[156:159], a[108:111], a[12:15]
  ds_read_b64_tr_b16 a[172:173], v9 offset:13312
  v_mfma_f32_16x16x32_bf16 v[188:191], a[156:159], a[104:107], v[188:191]
  v_mfma_f32_16x16x32_bf16 v[108:111], a[156:159], a[100:103], v[108:111]
  ds_read_b64_tr_b16 a[174:175], v9 offset:16896
  v_mfma_f32_16x16x32_bf16 v[28:31], a[156:159], a[96:99], v[28:31]
  s_waitcnt lgkmcnt(6)
  v_mfma_f32_16x16x32_bf16 v[32:35], a[96:99], a[160:163], v[32:35]
  ds_read_b64_tr_b16 a[176:177], v9 offset:6176
  v_mfma_f32_16x16x32_bf16 v[112:115], a[100:103], a[160:163], v[112:115]
  v_mfma_f32_16x16x32_bf16 v[192:195], a[104:107], a[160:163], v[192:195]
  ds_read_b64_tr_b16 a[178:179], v9 offset:9760
  v_mfma_f32_16x16x32_bf16 a[16:19], a[108:111], a[160:163], a[16:19]
  s_waitcnt lgkmcnt(6)
  v_mfma_f32_16x16x32_bf16 a[20:23], a[108:111], a[164:167], a[20:23]
  ds_read_b64_tr_b16 a[180:181], v9 offset:13344
  v_mfma_f32_16x16x32_bf16 v[196:199], a[104:107], a[164:167], v[196:199]
  v_mfma_f32_16x16x32_bf16 v[116:119], a[100:103], a[164:167], v[116:119]
  ds_read_b64_tr_b16 a[182:183], v9 offset:16928
  v_mfma_f32_16x16x32_bf16 v[36:39], a[96:99], a[164:167], v[36:39]
  s_waitcnt lgkmcnt(6)
  v_mfma_f32_16x16x32_bf16 v[40:43], a[168:171], a[96:99], v[40:43]
  ds_read_b64_tr_b16 a[144:145], v9 offset:6208
  v_mfma_f32_16x16x32_bf16 v[120:123], a[168:171], a[100:103], v[120:123]
  buffer_store_dwordx4 v[12:15], v1, s[84:87], s88 offen offset:1024 sc1
  v_mfma_f32_16x16x32_bf16 v[200:203], a[168:171], a[104:107], v[200:203]
  ds_read_b64_tr_b16 a[146:147], v9 offset:9792
  v_mfma_f32_16x16x32_bf16 a[24:27], a[168:171], a[108:111], a[24:27]
  s_waitcnt lgkmcnt(6)
  v_mfma_f32_16x16x32_bf16 a[28:31], a[172:175], a[108:111], a[28:31]
  ds_read_b64_tr_b16 a[148:149], v9 offset:13376
  v_mfma_f32_16x16x32_bf16 v[204:207], a[172:175], a[104:107], v[204:207]
  v_mfma_f32_16x16x32_bf16 v[124:127], a[172:175], a[100:103], v[124:127]
  ds_read_b64_tr_b16 a[150:151], v9 offset:16960
  v_mfma_f32_16x16x32_bf16 v[44:47], a[172:175], a[96:99], v[44:47]
  s_cmp_eq_u32 s45, 81920
  s_cselect_b32 s50, s66, s67
  s_waitcnt lgkmcnt(6)
  v_mfma_f32_16x16x32_bf16 v[48:51], a[176:179], a[96:99], v[48:51]
  ds_read_b64_tr_b16 a[152:153], v9 offset:6240
  v_mfma_f32_16x16x32_bf16 v[128:131], a[176:179], a[100:103], v[128:131]
  v_mfma_f32_16x16x32_bf16 v[208:211], a[176:179], a[104:107], v[208:211]
  ds_read_b64_tr_b16 a[154:155], v9 offset:9824
  v_mfma_f32_16x16x32_bf16 a[32:35], a[176:179], a[108:111], a[32:35]
  s_add_u32 s45, s45, s50
  s_waitcnt lgkmcnt(6)
  v_mfma_f32_16x16x32_bf16 a[36:39], a[180:183], a[108:111], a[36:39]
  ds_read_b64_tr_b16 a[156:157], v9 offset:13408
  v_mfma_f32_16x16x32_bf16 v[212:215], a[180:183], a[104:107], v[212:215]
  v_add_u32 v7, s50, v7
  v_mfma_f32_16x16x32_bf16 v[132:135], a[180:183], a[100:103], v[132:135]
  ds_read_b64_tr_b16 a[158:159], v9 offset:16992
  v_mfma_f32_16x16x32_bf16 v[52:55], a[180:183], a[96:99], v[52:55]
  v_add_u32 v8, s50, v8
  s_waitcnt lgkmcnt(6)
  v_mfma_f32_16x16x32_bf16 v[56:59], a[144:147], a[96:99], v[56:59]
  ds_read_b64_tr_b16 a[160:161], v9 offset:6272
  v_mfma_f32_16x16x32_bf16 v[136:139], a[144:147], a[100:103], v[136:139]
  buffer_store_dwordx4 v[12:15], v1, s[84:87], s88 offen offset:2048 sc1
  v_mfma_f32_16x16x32_bf16 v[216:219], a[144:147], a[104:107], v[216:219]
  ds_read_b64_tr_b16 a[162:163], v9 offset:9856
  v_mfma_f32_16x16x32_bf16 a[40:43], a[144:147], a[108:111], a[40:43]
  s_waitcnt lgkmcnt(6)
  v_mfma_f32_16x16x32_bf16 a[44:47], a[148:151], a[108:111], a[44:47]
  ds_read_b64_tr_b16 a[164:165], v9 offset:13440
  v_mfma_f32_16x16x32_bf16 v[220:223], a[148:151], a[104:107], v[220:223]
  v_mfma_f32_16x16x32_bf16 v[140:143], a[148:151], a[100:103], v[140:143]
  ds_read_b64_tr_b16 a[166:167], v9 offset:17024
  v_mfma_f32_16x16x32_bf16 v[60:63], a[148:151], a[96:99], v[60:63]
  s_waitcnt lgkmcnt(6)
  v_mfma_f32_16x16x32_bf16 v[64:67], a[152:155], a[96:99], v[64:67]
  ds_read_b64_tr_b16 a[168:169], v9 offset:6304
  v_mfma_f32_16x16x32_bf16 v[144:147], a[152:155], a[100:103], v[144:147]
  v_mfma_f32_16x16x32_bf16 v[224:227], a[152:155], a[104:107], v[224:227]
  ds_read_b64_tr_b16 a[170:171], v9 offset:9888
  v_mfma_f32_16x16x32_bf16 a[48:51], a[152:155], a[108:111], a[48:51]
  s_waitcnt lgkmcnt(6)
  v_mfma_f32_16x16x32_bf16 a[52:55], a[156:159], a[108:111], a[52:55]
  ds_read_b64_tr_b16 a[172:173], v9 offset:13472
  v_mfma_f32_16x16x32_bf16 v[228:231], a[156:159], a[104:107], v[228:231]
  v_mfma_f32_16x16x32_bf16 v[148:151], a[156:159], a[100:103], v[148:151]
  ds_read_b64_tr_b16 a[174:175], v9 offset:17056
  v_mfma_f32_16x16x32_bf16 v[68:71], a[156:159], a[96:99], v[68:71]
  s_waitcnt lgkmcnt(6)
  v_mfma_f32_16x16x32_bf16 v[72:75], a[160:163], a[96:99], v[72:75]
  ds_read_b64_tr_b16 a[176:177], v9 offset:6336
  v_mfma_f32_16x16x32_bf16 v[152:155], a[160:163], a[100:103], v[152:155]
  buffer_store_dwordx4 v[12:15], v1, s[84:87], s88 offen offset:3072 sc1
  v_mfma_f32_16x16x32_bf16 v[232:235], a[160:163], a[104:107], v[232:235]
  ds_read_b64_tr_b16 a[178:179], v9 offset:9920
  v_mfma_f32_16x16x32_bf16 a[56:59], a[160:163], a[108:111], a[56:59]
  s_waitcnt lgkmcnt(6)
  v_mfma_f32_16x16x32_bf16 a[60:63], a[164:167], a[108:111], a[60:63]
  ds_read_b64_tr_b16 a[180:181], v9 offset:13504
  v_mfma_f32_16x16x32_bf16 v[236:239], a[164:167], a[104:107], v[236:239]
  v_mfma_f32_16x16x32_bf16 v[156:159], a[164:167], a[100:103], v[156:159]
  ds_read_b64_tr_b16 a[182:183], v9 offset:17088
  v_mfma_f32_16x16x32_bf16 v[76:79], a[164:167], a[96:99], v[76:79]
  v_add_u32 v9, s50, v9
  s_waitcnt lgkmcnt(6)
  v_mfma_f32_16x16x32_bf16 v[80:83], a[168:171], a[96:99], v[80:83]
  ds_read_b64_tr_b16 a[144:145], v7 offset:0
  v_mfma_f32_16x16x32_bf16 v[160:163], a[168:171], a[100:103], v[160:163]
  v_mfma_f32_16x16x32_bf16 v[240:243], a[168:171], a[104:107], v[240:243]
  ds_read_b64_tr_b16 a[146:147], v7 offset:3072
  v_mfma_f32_16x16x32_bf16 a[64:67], a[168:171], a[108:111], a[64:67]
  s_waitcnt lgkmcnt(6)
  v_mfma_f32_16x16x32_bf16 a[68:71], a[172:175], a[108:111], a[68:71]
  ds_read_b64_tr_b16 a[148:149], v8 offset:0
  v_mfma_f32_16x16x32_bf16 v[244:247], a[172:175], a[104:107], v[244:247]
  v_mfma_f32_16x16x32_bf16 v[164:167], a[172:175], a[100:103], v[164:167]
  ds_read_b64_tr_b16 a[150:151], v8 offset:3072
  v_mfma_f32_16x16x32_bf16 v[84:87], a[172:175], a[96:99], v[84:87]
  s_waitcnt lgkmcnt(6)
  v_mfma_f32_16x16x32_bf16 v[88:91], a[176:179], a[96:99], v[88:91]
  ds_read_b64_tr_b16 a[152:153], v7 offset:64
  v_mfma_f32_16x16x32_bf16 v[168:171], a[176:179], a[100:103], v[168:171]
  v_mfma_f32_16x16x32_bf16 v[248:251], a[176:179], a[104:107], v[248:251]
  ds_read_b64_tr_b16 a[154:155], v7 offset:3136
  v_mfma_f32_16x16x32_bf16 a[72:75], a[176:179], a[108:111], a[72:75]
  s_waitcnt lgkmcnt(6)
  v_mfma_f32_16x16x32_bf16 a[76:79], a[180:183], a[108:111], a[76:79]
  ds_read_b64_tr_b16 a[156:157], v8 offset:64
  v_mfma_f32_16x16x32_bf16 v[252:255], a[180:183], a[104:107], v[252:255]
  v_mfma_f32_16x16x32_bf16 v[172:175], a[180:183], a[100:103], v[172:175]
  ds_read_b64_tr_b16 a[158:159], v8 offset:3136
  v_mfma_f32_16x16x32_bf16 v[92:95], a[180:183], a[96:99], v[92:95]
  s_waitcnt vmcnt(10)
  s_barrier
  s_waitcnt lgkmcnt(6)
  v_mfma_f32_16x16x32_bf16 v[16:19], a[144:147], a[112:115], v[16:19]
  ds_read_b64_tr_b16 a[160:161], v7 offset:128
  v_mfma_f32_16x16x32_bf16 v[96:99], a[144:147], a[116:119], v[96:99]
  v_mfma_f32_16x16x32_bf16 v[176:179], a[144:147], a[120:123], v[176:179]
  ds_read_b64_tr_b16 a[162:163], v7 offset:3200
  v_mfma_f32_16x16x32_bf16 a[0:3], a[144:147], a[124:127], a[0:3]
  s_waitcnt lgkmcnt(6)
  v_mfma_f32_16x16x32_bf16 a[4:7], a[148:151], a[124:127], a[4:7]
  ds_read_b64_tr_b16 a[164:165], v8 offset:128
  v_mfma_f32_16x16x32_bf16 v[180:183], a[148:151], a[120:123], v[180:183]
  v_mfma_f32_16x16x32_bf16 v[100:103], a[148:151], a[116:119], v[100:103]
  ds_read_b64_tr_b16 a[166:167], v8 offset:3200
  v_mfma_f32_16x16x32_bf16 v[20:23], a[148:151], a[112:115], v[20:23]
  s_waitcnt lgkmcnt(6)
  v_mfma_f32_16x16x32_bf16 v[24:27], a[152:155], a[112:115], v[24:27]
  ds_read_b64_tr_b16 a[168:169], v9 offset:6144
  v_mfma_f32_16x16x32_bf16 v[104:107], a[152:155], a[116:119], v[104:107]
  v_mfma_f32_16x16x32_bf16 v[184:187], a[152:155], a[120:123], v[184:187]
  ds_read_b64_tr_b16 a[170:171], v9 offset:9728
  v_mfma_f32_16x16x32_bf16 a[8:11], a[152:155], a[124:127], a[8:11]
  s_waitcnt lgkmcnt(6)
  v_mfma_f32_16x16x32_bf16 a[12:15], a[156:159], a[124:127], a[12:15]
  ds_read_b64_tr_b16 a[172:173], v9 offset:13312
  v_mfma_f32_16x16x32_bf16 v[188:191], a[156:159], a[120:123], v[188:191]
  v_mfma_f32_16x16x32_bf16 v[108:111], a[156:159], a[116:119], v[108:111]
  ds_read_b64_tr_b16 a[174:175], v9 offset:16896
  v_mfma_f32_16x16x32_bf16 v[28:31], a[156:159], a[112:115], v[28:31]
  s_waitcnt lgkmcnt(6)
  v_mfma_f32_16x16x32_bf16 v[32:35], a[112:115], a[160:163], v[32:35]
  ds_read_b64_tr_b16 a[176:177], v9 offset:6176
  v_mfma_f32_16x16x32_bf16 v[112:115], a[116:119], a[160:163], v[112:115]
  v_mfma_f32_16x16x32_bf16 v[192:195], a[120:123], a[160:163], v[192:195]
  ds_read_b64_tr_b16 a[178:179], v9 offset:9760
  v_mfma_f32_16x16x32_bf16 a[16:19], a[124:127], a[160:163], a[16:19]
  s_waitcnt lgkmcnt(6)
  v_mfma_f32_16x16x32_bf16 a[20:23], a[124:127], a[164:167], a[20:23]
  ds_read_b64_tr_b16 a[180:181], v9 offset:13344
  v_mfma_f32_16x16x32_bf16 v[196:199], a[120:123], a[164:167], v[196:199]
  v_mfma_f32_16x16x32_bf16 v[116:119], a[116:119], a[164:167], v[116:119]
  ds_read_b64_tr_b16 a[182:183], v9 offset:16928
  v_mfma_f32_16x16x32_bf16 v[36:39], a[112:115], a[164:167], v[36:39]
  s_waitcnt lgkmcnt(6)
  v_mfma_f32_16x16x32_bf16 v[40:43], a[168:171], a[112:115], v[40:43]
  ds_read_b64_tr_b16 a[144:145], v9 offset:6208
  v_mfma_f32_16x16x32_bf16 v[120:123], a[168:171], a[116:119], v[120:123]
  v_mfma_f32_16x16x32_bf16 v[200:203], a[168:171], a[120:123], v[200:203]
  ds_read_b64_tr_b16 a[146:147], v9 offset:9792
  v_mfma_f32_16x16x32_bf16 a[24:27], a[168:171], a[124:127], a[24:27]
  s_waitcnt lgkmcnt(6)
  v_mfma_f32_16x16x32_bf16 a[28:31], a[172:175], a[124:127], a[28:31]
  ds_read_b64_tr_b16 a[148:149], v9 offset:13376
  v_mfma_f32_16x16x32_bf16 v[204:207], a[172:175], a[120:123], v[204:207]
  v_mfma_f32_16x16x32_bf16 v[124:127], a[172:175], a[116:119], v[124:127]
  ds_read_b64_tr_b16 a[150:151], v9 offset:16960
  v_mfma_f32_16x16x32_bf16 v[44:47], a[172:175], a[112:115], v[44:47]
  s_cmp_eq_u32 s45, 81920
  s_cselect_b32 s50, s66, s67
  s_waitcnt lgkmcnt(6)
  v_mfma_f32_16x16x32_bf16 v[48:51], a[176:179], a[112:115], v[48:51]
  ds_read_b64_tr_b16 a[152:153], v9 offset:6240
  v_mfma_f32_16x16x32_bf16 v[128:131], a[176:179], a[116:119], v[128:131]
  v_mfma_f32_16x16x32_bf16 v[208:211], a[176:179], a[120:123], v[208:211]
  ds_read_b64_tr_b16 a[154:155], v9 offset:9824
  v_mfma_f32_16x16x32_bf16 a[32:35], a[176:179], a[124:127], a[32:35]
  s_add_u32 s45, s45, s50
  s_waitcnt lgkmcnt(6)
  v_mfma_f32_16x16x32_bf16 a[36:39], a[180:183], a[124:127], a[36:39]
  ds_read_b64_tr_b16 a[156:157], v9 offset:13408
  v_mfma_f32_16x16x32_bf16 v[212:215], a[180:183], a[120:123], v[212:215]
  v_add_u32 v7, s50, v7
  v_mfma_f32_16x16x32_bf16 v[132:135], a[180:183], a[116:119], v[132:135]
  ds_read_b64_tr_b16 a[158:159], v9 offset:16992
  v_mfma_f32_16x16x32_bf16 v[52:55], a[180:183], a[112:115], v[52:55]
  v_add_u32 v8, s50, v8
  s_waitcnt lgkmcnt(6)
  v_mfma_f32_16x16x32_bf16 v[56:59], a[144:147], a[112:115], v[56:59]
  ds_read_b64_tr_b16 a[160:161], v9 offset:6272
  v_mfma_f32_16x16x32_bf16 v[136:139], a[144:147], a[116:119], v[136:139]
  v_mfma_f32_16x16x32_bf16 v[216:219], a[144:147], a[120:123], v[216:219]
  ds_read_b64_tr_b16 a[162:163], v9 offset:9856
  v_mfma_f32_16x16x32_bf16 a[40:43], a[144:147], a[124:127], a[40:43]
  s_waitcnt lgkmcnt(6)
  v_mfma_f32_16x16x32_bf16 a[44:47], a[148:151], a[124:127], a[44:47]
  ds_read_b64_tr_b16 a[164:165], v9 offset:13440
  v_mfma_f32_16x16x32_bf16 v[220:223], a[148:151], a[120:123], v[220:223]
  v_mfma_f32_16x16x32_bf16 v[140:143], a[148:151], a[116:119], v[140:143]
  ds_read_b64_tr_b16 a[166:167], v9 offset:17024
  v_mfma_f32_16x16x32_bf16 v[60:63], a[148:151], a[112:115], v[60:63]
  s_waitcnt lgkmcnt(6)
  v_mfma_f32_16x16x32_bf16 v[64:67], a[152:155], a[112:115], v[64:67]
  ds_read_b64_tr_b16 a[168:169], v9 offset:6304
  v_mfma_f32_16x16x32_bf16 v[144:147], a[152:155], a[116:119], v[144:147]
  v_mfma_f32_16x16x32_bf16 v[224:227], a[152:155], a[120:123], v[224:227]
  ds_read_b64_tr_b16 a[170:171], v9 offset:9888
  v_mfma_f32_16x16x32_bf16 a[48:51], a[152:155], a[124:127], a[48:51]
  s_waitcnt lgkmcnt(6)
  v_mfma_f32_16x16x32_bf16 a[52:55], a[156:159], a[124:127], a[52:55]
  ds_read_b64_tr_b16 a[172:173], v9 offset:13472
  v_mfma_f32_16x16x32_bf16 v[228:231], a[156:159], a[120:123], v[228:231]
  v_mfma_f32_16x16x32_bf16 v[148:151], a[156:159], a[116:119], v[148:151]
  ds_read_b64_tr_b16 a[174:175], v9 offset:17056
  v_mfma_f32_16x16x32_bf16 v[68:71], a[156:159], a[112:115], v[68:71]
  s_waitcnt lgkmcnt(6)
  v_mfma_f32_16x16x32_bf16 v[72:75], a[160:163], a[112:115], v[72:75]
  ds_read_b64_tr_b16 a[176:177], v9 offset:6336
  v_mfma_f32_16x16x32_bf16 v[152:155], a[160:163], a[116:119], v[152:155]
  v_mfma_f32_16x16x32_bf16 v[232:235], a[160:163], a[120:123], v[232:235]
  ds_read_b64_tr_b16 a[178:179], v9 offset:9920
  v_mfma_f32_16x16x32_bf16 a[56:59], a[160:163], a[124:127], a[56:59]
  s_waitcnt lgkmcnt(6)
  v_mfma_f32_16x16x32_bf16 a[60:63], a[164:167], a[124:127], a[60:63]
  ds_read_b64_tr_b16 a[180:181], v9 offset:13504
  v_mfma_f32_16x16x32_bf16 v[236:239], a[164:167], a[120:123], v[236:239]
  v_mfma_f32_16x16x32_bf16 v[156:159], a[164:167], a[116:119], v[156:159]
  ds_read_b64_tr_b16 a[182:183], v9 offset:17088
  v_mfma_f32_16x16x32_bf16 v[76:79], a[164:167], a[112:115], v[76:79]
  v_add_u32 v9, s50, v9
  s_waitcnt lgkmcnt(6)
  v_mfma_f32_16x16x32_bf16 v[80:83], a[168:171], a[112:115], v[80:83]
  ds_read_b64_tr_b16 a[144:145], v7 offset:0
  v_mfma_f32_16x16x32_bf16 v[160:163], a[168:171], a[116:119], v[160:163]
  v_mfma_f32_16x16x32_bf16 v[240:243], a[168:171], a[120:123], v[240:243]
  ds_read_b64_tr_b16 a[146:147], v7 offset:3072
  v_mfma_f32_16x16x32_bf16 a[64:67], a[168:171], a[124:127], a[64:67]
  s_waitcnt lgkmcnt(6)
  v_mfma_f32_16x16x32_bf16 a[68:71], a[172:175], a[124:127], a[68:71]
  ds_read_b64_tr_b16 a[148:149], v8 offset:0
  v_mfma_f32_16x16x32_bf16 v[244:247], a[172:175], a[120:123], v[244:247]
  v_mfma_f32_16x16x32_bf16 v[164:167], a[172:175], a[116:119], v[164:167]
  ds_read_b64_tr_b16 a[150:151], v8 offset:3072
  v_mfma_f32_16x16x32_bf16 v[84:87], a[172:175], a[112:115], v[84:87]
  s_waitcnt lgkmcnt(6)
  v_mfma_f32_16x16x32_bf16 v[88:91], a[176:179], a[112:115], v[88:91]
  ds_read_b64_tr_b16 a[152:153], v7 offset:64
  v_mfma_f32_16x16x32_bf16 v[168:171], a[176:179], a[116:119], v[168:171]
  v_mfma_f32_16x16x32_bf16 v[248:251], a[176:179], a[120:123], v[248:251]
  ds_read_b64_tr_b16 a[154:155], v7 offset:3136
  v_mfma_f32_16x16x32_bf16 a[72:75], a[176:179], a[124:127], a[72:75]
  s_waitcnt lgkmcnt(6)
  v_mfma_f32_16x16x32_bf16 a[76:79], a[180:183], a[124:127], a[76:79]
  ds_read_b64_tr_b16 a[156:157], v8 offset:64
  v_mfma_f32_16x16x32_bf16 v[252:255], a[180:183], a[120:123], v[252:255]
  v_mfma_f32_16x16x32_bf16 v[172:175], a[180:183], a[116:119], v[172:175]
  ds_read_b64_tr_b16 a[158:159], v8 offset:3136
  v_mfma_f32_16x16x32_bf16 v[92:95], a[180:183], a[112:115], v[92:95]
  s_waitcnt vmcnt(6)
  s_barrier
  s_waitcnt lgkmcnt(6)
  v_mfma_f32_16x16x32_bf16 v[16:19], a[144:147], a[128:131], v[16:19]
  ds_read_b64_tr_b16 a[160:161], v7 offset:128
  v_mfma_f32_16x16x32_bf16 v[96:99], a[144:147], a[132:135], v[96:99]
  v_mfma_f32_16x16x32_bf16 v[176:179], a[144:147], a[136:139], v[176:179]
  ds_read_b64_tr_b16 a[162:163], v7 offset:3200
  v_mfma_f32_16x16x32_bf16 a[0:3], a[144:147], a[140:143], a[0:3]
  s_waitcnt lgkmcnt(6)
  v_mfma_f32_16x16x32_bf16 a[4:7], a[148:151], a[140:143], a[4:7]
  ds_read_b64_tr_b16 a[164:165], v8 offset:128
  v_mfma_f32_16x16x32_bf16 v[180:183], a[148:151], a[136:139], v[180:183]
  v_mfma_f32_16x16x32_bf16 v[100:103], a[148:151], a[132:135], v[100:103]
  ds_read_b64_tr_b16 a[166:167], v8 offset:3200
  v_mfma_f32_16x16x32_bf16 v[20:23], a[148:151], a[128:131], v[20:23]
  s_waitcnt lgkmcnt(6)
  v_mfma_f32_16x16x32_bf16 v[24:27], a[152:155], a[128:131], v[24:27]
  ds_read_b64_tr_b16 a[168:169], v9 offset:6144
  v_mfma_f32_16x16x32_bf16 v[104:107], a[152:155], a[132:135], v[104:107]
  v_mfma_f32_16x16x32_bf16 v[184:187], a[152:155], a[136:139], v[184:187]
  ds_read_b64_tr_b16 a[170:171], v9 offset:9728
  v_mfma_f32_16x16x32_bf16 a[8:11], a[152:155], a[140:143], a[8:11]
  s_waitcnt lgkmcnt(6)
  v_mfma_f32_16x16x32_bf16 a[12:15], a[156:159], a[140:143], a[12:15]
  ds_read_b64_tr_b16 a[172:173], v9 offset:13312
  v_mfma_f32_16x16x32_bf16 v[188:191], a[156:159], a[136:139], v[188:191]
  v_mfma_f32_16x16x32_bf16 v[108:111], a[156:159], a[132:135], v[108:111]
  ds_read_b64_tr_b16 a[174:175], v9 offset:16896
  v_mfma_f32_16x16x32_bf16 v[28:31], a[156:159], a[128:131], v[28:31]
  s_waitcnt lgkmcnt(6)
  v_mfma_f32_16x16x32_bf16 v[32:35], a[128:131], a[160:163], v[32:35]
  ds_read_b64_tr_b16 a[176:177], v9 offset:6176
  v_mfma_f32_16x16x32_bf16 v[112:115], a[132:135], a[160:163], v[112:115]
  v_mfma_f32_16x16x32_bf16 v[192:195], a[136:139], a[160:163], v[192:195]
  ds_read_b64_tr_b16 a[178:179], v9 offset:9760
  v_mfma_f32_16x16x32_bf16 a[16:19], a[140:143], a[160:163], a[16:19]
  s_waitcnt lgkmcnt(6)
  v_mfma_f32_16x16x32_bf16 a[20:23], a[140:143], a[164:167], a[20:23]
  ds_read_b64_tr_b16 a[180:181], v9 offset:13344
  v_mfma_f32_16x16x32_bf16 v[196:199], a[136:139], a[164:167], v[196:199]
  v_mfma_f32_16x16x32_bf16 v[116:119], a[132:135], a[164:167], v[116:119]
  ds_read_b64_tr_b16 a[182:183], v9 offset:16928
  v_mfma_f32_16x16x32_bf16 v[36:39], a[128:131], a[164:167], v[36:39]
  s_waitcnt lgkmcnt(6)
  v_mfma_f32_16x16x32_bf16 v[40:43], a[168:171], a[128:131], v[40:43]
  ds_read_b64_tr_b16 a[144:145], v9 offset:6208
  v_mfma_f32_16x16x32_bf16 v[120:123], a[168:171], a[132:135], v[120:123]
  v_mfma_f32_16x16x32_bf16 v[200:203], a[168:171], a[136:139], v[200:203]
  ds_read_b64_tr_b16 a[146:147], v9 offset:9792
  v_mfma_f32_16x16x32_bf16 a[24:27], a[168:171], a[140:143], a[24:27]
  s_waitcnt lgkmcnt(6)
  v_mfma_f32_16x16x32_bf16 a[28:31], a[172:175], a[140:143], a[28:31]
  ds_read_b64_tr_b16 a[148:149], v9 offset:13376
  v_mfma_f32_16x16x32_bf16 v[204:207], a[172:175], a[136:139], v[204:207]
  v_mfma_f32_16x16x32_bf16 v[124:127], a[172:175], a[132:135], v[124:127]
  ds_read_b64_tr_b16 a[150:151], v9 offset:16960
  v_mfma_f32_16x16x32_bf16 v[44:47], a[172:175], a[128:131], v[44:47]
  s_cmp_eq_u32 s45, 81920
  s_cselect_b32 s50, s66, s67
  s_waitcnt lgkmcnt(6)
  v_mfma_f32_16x16x32_bf16 v[48:51], a[176:179], a[128:131], v[48:51]
  ds_read_b64_tr_b16 a[152:153], v9 offset:6240
  v_mfma_f32_16x16x32_bf16 v[128:131], a[176:179], a[132:135], v[128:131]
  v_mfma_f32_16x16x32_bf16 v[208:211], a[176:179], a[136:139], v[208:211]
  ds_read_b64_tr_b16 a[154:155], v9 offset:9824
  v_mfma_f32_16x16x32_bf16 a[32:35], a[176:179], a[140:143], a[32:35]
  s_add_u32 s45, s45, s50
  s_waitcnt lgkmcnt(6)
  v_mfma_f32_16x16x32_bf16 a[36:39], a[180:183], a[140:143], a[36:39]
  ds_read_b64_tr_b16 a[156:157], v9 offset:13408
  v_mfma_f32_16x16x32_bf16 v[212:215], a[180:183], a[136:139], v[212:215]
  v_add_u32 v7, s50, v7
  v_mfma_f32_16x16x32_bf16 v[132:135], a[180:183], a[132:135], v[132:135]
  ds_read_b64_tr_b16 a[158:159], v9 offset:16992
  v_mfma_f32_16x16x32_bf16 v[52:55], a[180:183], a[128:131], v[52:55]
  v_add_u32 v8, s50, v8
  s_waitcnt lgkmcnt(6)
  v_mfma_f32_16x16x32_bf16 v[56:59], a[144:147], a[128:131], v[56:59]
  ds_read_b64_tr_b16 a[160:161], v9 offset:6272
  v_mfma_f32_16x16x32_bf16 v[136:139], a[144:147], a[132:135], v[136:139]
  v_mfma_f32_16x16x32_bf16 v[216:219], a[144:147], a[136:139], v[216:219]
  ds_read_b64_tr_b16 a[162:163], v9 offset:9856
  v_mfma_f32_16x16x32_bf16 a[40:43], a[144:147], a[140:143], a[40:43]
  s_waitcnt lgkmcnt(6)
  v_mfma_f32_16x16x32_bf16 a[44:47], a[148:151], a[140:143], a[44:47]
  ds_read_b64_tr_b16 a[164:165], v9 offset:13440
  v_mfma_f32_16x16x32_bf16 v[220:223], a[148:151], a[136:139], v[220:223]
  v_mfma_f32_16x16x32_bf16 v[140:143], a[148:151], a[132:135], v[140:143]
  ds_read_b64_tr_b16 a[166:167], v9 offset:17024
  v_mfma_f32_16x16x32_bf16 v[60:63], a[148:151], a[128:131], v[60:63]
  s_waitcnt lgkmcnt(6)
  v_mfma_f32_16x16x32_bf16 v[64:67], a[152:155], a[128:131], v[64:67]
  ds_read_b64_tr_b16 a[168:169], v9 offset:6304
  v_mfma_f32_16x16x32_bf16 v[144:147], a[152:155], a[132:135], v[144:147]
  v_mfma_f32_16x16x32_bf16 v[224:227], a[152:155], a[136:139], v[224:227]
  ds_read_b64_tr_b16 a[170:171], v9 offset:9888
  v_mfma_f32_16x16x32_bf16 a[48:51], a[152:155], a[140:143], a[48:51]
  s_waitcnt lgkmcnt(6)
  v_mfma_f32_16x16x32_bf16 a[52:55], a[156:159], a[140:143], a[52:55]
  ds_read_b64_tr_b16 a[172:173], v9 offset:13472
  v_mfma_f32_16x16x32_bf16 v[228:231], a[156:159], a[136:139], v[228:231]
  v_mfma_f32_16x16x32_bf16 v[148:151], a[156:159], a[132:135], v[148:151]
  ds_read_b64_tr_b16 a[174:175], v9 offset:17056
  v_mfma_f32_16x16x32_bf16 v[68:71], a[156:159], a[128:131], v[68:71]
  s_waitcnt lgkmcnt(6)
  v_mfma_f32_16x16x32_bf16 v[72:75], a[160:163], a[128:131], v[72:75]
  ds_read_b64_tr_b16 a[176:177], v9 offset:6336
  v_mfma_f32_16x16x32_bf16 v[152:155], a[160:163], a[132:135], v[152:155]
  v_mfma_f32_16x16x32_bf16 v[232:235], a[160:163], a[136:139], v[232:235]
  ds_read_b64_tr_b16 a[178:179], v9 offset:9920
  v_mfma_f32_16x16x32_bf16 a[56:59], a[160:163], a[140:143], a[56:59]
  s_waitcnt lgkmcnt(6)
  v_mfma_f32_16x16x32_bf16 a[60:63], a[164:167], a[140:143], a[60:63]
  ds_read_b64_tr_b16 a[180:181], v9 offset:13504
  v_mfma_f32_16x16x32_bf16 v[236:239], a[164:167], a[136:139], v[236:239]
  v_mfma_f32_16x16x32_bf16 v[156:159], a[164:167], a[132:135], v[156:159]
  ds_read_b64_tr_b16 a[182:183], v9 offset:17088
  v_mfma_f32_16x16x32_bf16 v[76:79], a[164:167], a[128:131], v[76:79]
  v_add_u32 v9, s50, v9
  s_waitcnt lgkmcnt(6)
  v_mfma_f32_16x16x32_bf16 v[80:83], a[168:171], a[128:131], v[80:83]
  v_mfma_f32_16x16x32_bf16 v[160:163], a[168:171], a[132:135], v[160:163]
  v_mfma_f32_16x16x32_bf16 v[240:243], a[168:171], a[136:139], v[240:243]
  v_mfma_f32_16x16x32_bf16 a[64:67], a[168:171], a[140:143], a[64:67]
  s_waitcnt lgkmcnt(4)
  v_mfma_f32_16x16x32_bf16 a[68:71], a[172:175], a[140:143], a[68:71]
  v_mfma_f32_16x16x32_bf16 v[244:247], a[172:175], a[136:139], v[244:247]
  v_mfma_f32_16x16x32_bf16 v[164:167], a[172:175], a[132:135], v[164:167]
  v_mfma_f32_16x16x32_bf16 v[84:87], a[172:175], a[128:131], v[84:87]
  s_waitcnt lgkmcnt(2)
  v_mfma_f32_16x16x32_bf16 v[88:91], a[176:179], a[128:131], v[88:91]
  v_mfma_f32_16x16x32_bf16 v[168:171], a[176:179], a[132:135], v[168:171]
  v_mfma_f32_16x16x32_bf16 v[248:251], a[176:179], a[136:139], v[248:251]
  v_mfma_f32_16x16x32_bf16 a[72:75], a[176:179], a[140:143], a[72:75]
  s_waitcnt lgkmcnt(0)
  v_mfma_f32_16x16x32_bf16 a[76:79], a[180:183], a[140:143], a[76:79]
  v_mfma_f32_16x16x32_bf16 v[252:255], a[180:183], a[136:139], v[252:255]
  v_mfma_f32_16x16x32_bf16 v[172:175], a[180:183], a[132:135], v[172:175]
  v_mfma_f32_16x16x32_bf16 v[92:95], a[180:183], a[128:131], v[92:95]
  s_waitcnt lgkmcnt(0)
  s_barrier
  s_nop 7
  s_add_u32 s8, s62, 4194304
  s_addc_u32 s9, s63, 0
  s_mov_b32 s10, 18874368
  s_mov_b32 s11, 0x00020000
  s_lshl_b32 s52, s49, 4
  s_lshl_b32 s53, s47, 2
  s_add_u32 s52, s52, s53
  s_mul_i32 s53, s48, 7
  s_lshr_b32 s53, s53, 1
  s_add_u32 s53, s53, 32
  s_lshl_b32 s53, s53, 10
  s_mul_i32 s54, s52, 147456
  s_add_u32 s54, s54, s53
  v_max_f32 v40, 0, v40
  v_max_f32 v41, 0, v41
  v_max_f32 v42, 0, v42
  v_max_f32 v43, 0, v43
  v_pk_mul_f32 v[40:41], v[40:41], v[44:45]
  v_pk_mul_f32 v[42:43], v[42:43], v[46:47]
  v_cvt_pk_bf16_f32 v40, v40, v41
  v_cvt_pk_bf16_f32 v41, v42, v43
  v_max_f32 v48, 0, v48
  v_max_f32 v49, 0, v49
  v_max_f32 v50, 0, v50
  v_max_f32 v51, 0, v51
  v_pk_mul_f32 v[48:49], v[48:49], v[52:53]
  v_pk_mul_f32 v[50:51], v[50:51], v[54:55]
  v_cvt_pk_bf16_f32 v42, v48, v49
  v_cvt_pk_bf16_f32 v43, v50, v51
  v_max_f32 v56, 0, v56
  v_max_f32 v57, 0, v57
  v_max_f32 v58, 0, v58
  v_max_f32 v59, 0, v59
  v_pk_mul_f32 v[56:57], v[56:57], v[60:61]
  v_pk_mul_f32 v[58:59], v[58:59], v[62:63]
  v_cvt_pk_bf16_f32 v44, v56, v57
  v_cvt_pk_bf16_f32 v45, v58, v59
  v_max_f32 v64, 0, v64
  v_max_f32 v65, 0, v65
  v_max_f32 v66, 0, v66
  v_max_f32 v67, 0, v67
  v_pk_mul_f32 v[64:65], v[64:65], v[68:69]
  v_pk_mul_f32 v[66:67], v[66:67], v[70:71]
  v_cvt_pk_bf16_f32 v46, v64, v65
  v_cvt_pk_bf16_f32 v47, v66, v67
  v_max_f32 v72, 0, v72
  v_max_f32 v73, 0, v73
  v_max_f32 v74, 0, v74
  v_max_f32 v75, 0, v75
  v_pk_mul_f32 v[72:73], v[72:73], v[76:77]
  v_pk_mul_f32 v[74:75], v[74:75], v[78:79]
  v_cvt_pk_bf16_f32 v48, v72, v73
  v_cvt_pk_bf16_f32 v49, v74, v75
  v_max_f32 v80, 0, v80
  v_max_f32 v81, 0, v81
  v_max_f32 v82, 0, v82
  v_max_f32 v83, 0, v83
  v_pk_mul_f32 v[80:81], v[80:81], v[84:85]
  v_pk_mul_f32 v[82:83], v[82:83], v[86:87]
  v_cvt_pk_bf16_f32 v50, v80, v81
  v_cvt_pk_bf16_f32 v51, v82, v83
  v_max_f32 v88, 0, v88
  v_max_f32 v89, 0, v89
  v_max_f32 v90, 0, v90
  v_max_f32 v91, 0, v91
  v_pk_mul_f32 v[88:89], v[88:89], v[92:93]
  v_pk_mul_f32 v[90:91], v[90:91], v[94:95]
  v_cvt_pk_bf16_f32 v52, v88, v89
  v_cvt_pk_bf16_f32 v53, v90, v91
  s_bitcmp1_b32 s48, 0
  s_cbranch_scc1 L_hodd0
  buffer_store_dwordx4 v[40:43], v1, s[8:11], s54 offen sc1
  buffer_store_dwordx4 v[44:47], v1, s[8:11], s54 offen offset:1024 sc1
  buffer_store_dwordx4 v[48:51], v1, s[8:11], s54 offen offset:2048 sc1
  buffer_store_dwordx2 v[52:53], v1, s[8:11], s54 offen offset:3072 sc1
  s_branch L_hdone0
L_hodd0:
  buffer_store_dwordx2 v[40:41], v1, s[8:11], s54 offen offset:8 sc1
  buffer_store_dwordx4 v[42:45], v1, s[8:11], s54 offen offset:1024 sc1
  buffer_store_dwordx4 v[46:49], v1, s[8:11], s54 offen offset:2048 sc1
  buffer_store_dwordx4 v[50:53], v1, s[8:11], s54 offen offset:3072 sc1
L_hdone0:
  s_add_u32 s54, s54, 147456
  v_max_f32 v120, 0, v120
  v_max_f32 v121, 0, v121
  v_max_f32 v122, 0, v122
  v_max_f32 v123, 0, v123
  v_pk_mul_f32 v[120:121], v[120:121], v[124:125]
  v_pk_mul_f32 v[122:123], v[122:123], v[126:127]
  v_cvt_pk_bf16_f32 v120, v120, v121
  v_cvt_pk_bf16_f32 v121, v122, v123
  v_max_f32 v128, 0, v128
  v_max_f32 v129, 0, v129
  v_max_f32 v130, 0, v130
  v_max_f32 v131, 0, v131
  v_pk_mul_f32 v[128:129], v[128:129], v[132:133]
  v_pk_mul_f32 v[130:131], v[130:131], v[134:135]
  v_cvt_pk_bf16_f32 v122, v128, v129
  v_cvt_pk_bf16_f32 v123, v130, v131
  v_max_f32 v136, 0, v136
  v_max_f32 v137, 0, v137
  v_max_f32 v138, 0, v138
  v_max_f32 v139, 0, v139
  v_pk_mul_f32 v[136:137], v[136:137], v[140:141]
  v_pk_mul_f32 v[138:139], v[138:139], v[142:143]
  v_cvt_pk_bf16_f32 v124, v136, v137
  v_cvt_pk_bf16_f32 v125, v138, v139
  v_max_f32 v144, 0, v144
  v_max_f32 v145, 0, v145
  v_max_f32 v146, 0, v146
  v_max_f32 v147, 0, v147
  v_pk_mul_f32 v[144:145], v[144:145], v[148:149]
  v_pk_mul_f32 v[146:147], v[146:147], v[150:151]
  v_cvt_pk_bf16_f32 v126, v144, v145
  v_cvt_pk_bf16_f32 v127, v146, v147
  v_max_f32 v152, 0, v152
  v_max_f32 v153, 0, v153
  v_max_f32 v154, 0, v154
  v_max_f32 v155, 0, v155
  v_pk_mul_f32 v[152:153], v[152:153], v[156:157]
  v_pk_mul_f32 v[154:155], v[154:155], v[158:159]
  v_cvt_pk_bf16_f32 v128, v152, v153
  v_cvt_pk_bf16_f32 v129, v154, v155
  v_max_f32 v160, 0, v160
  v_max_f32 v161, 0, v161
  v_max_f32 v162, 0, v162
  v_max_f32 v163, 0, v163
  v_pk_mul_f32 v[160:161], v[160:161], v[164:165]
  v_pk_mul_f32 v[162:163], v[162:163], v[166:167]
  v_cvt_pk_bf16_f32 v130, v160, v161
  v_cvt_pk_bf16_f32 v131, v162, v163
  v_max_f32 v168, 0, v168
  v_max_f32 v169, 0, v169
  v_max_f32 v170, 0, v170
  v_max_f32 v171, 0, v171
  v_pk_mul_f32 v[168:169], v[168:169], v[172:173]
  v_pk_mul_f32 v[170:171], v[170:171], v[174:175]
  v_cvt_pk_bf16_f32 v132, v168, v169
  v_cvt_pk_bf16_f32 v133, v170, v171
  s_bitcmp1_b32 s48, 0
  s_cbranch_scc1 L_hodd1
  buffer_store_dwordx4 v[120:123], v1, s[8:11], s54 offen sc1
  buffer_store_dwordx4 v[124:127], v1, s[8:11], s54 offen offset:1024 sc1
  buffer_store_dwordx4 v[128:131], v1, s[8:11], s54 offen offset:2048 sc1
  buffer_store_dwordx2 v[132:133], v1, s[8:11], s54 offen offset:3072 sc1
  s_branch L_hdone1
L_hodd1:
  buffer_store_dwordx2 v[120:121], v1, s[8:11], s54 offen offset:8 sc1
  buffer_store_dwordx4 v[122:125], v1, s[8:11], s54 offen offset:1024 sc1
  buffer_store_dwordx4 v[126:129], v1, s[8:11], s54 offen offset:2048 sc1
  buffer_store_dwordx4 v[130:133], v1, s[8:11], s54 offen offset:3072 sc1
L_hdone1:
  s_add_u32 s54, s54, 147456
  v_max_f32 v200, 0, v200
  v_max_f32 v201, 0, v201
  v_max_f32 v202, 0, v202
  v_max_f32 v203, 0, v203
  v_pk_mul_f32 v[200:201], v[200:201], v[204:205]
  v_pk_mul_f32 v[202:203], v[202:203], v[206:207]
  v_cvt_pk_bf16_f32 v200, v200, v201
  v_cvt_pk_bf16_f32 v201, v202, v203
  v_max_f32 v208, 0, v208
  v_max_f32 v209, 0, v209
  v_max_f32 v210, 0, v210
  v_max_f32 v211, 0, v211
  v_pk_mul_f32 v[208:209], v[208:209], v[212:213]
  v_pk_mul_f32 v[210:211], v[210:211], v[214:215]
  v_cvt_pk_bf16_f32 v202, v208, v209
  v_cvt_pk_bf16_f32 v203, v210, v211
  v_max_f32 v216, 0, v216
  v_max_f32 v217, 0, v217
  v_max_f32 v218, 0, v218
  v_max_f32 v219, 0, v219
  v_pk_mul_f32 v[216:217], v[216:217], v[220:221]
  v_pk_mul_f32 v[218:219], v[218:219], v[222:223]
  v_cvt_pk_bf16_f32 v204, v216, v217
  v_cvt_pk_bf16_f32 v205, v218, v219
  v_max_f32 v224, 0, v224
  v_max_f32 v225, 0, v225
  v_max_f32 v226, 0, v226
  v_max_f32 v227, 0, v227
  v_pk_mul_f32 v[224:225], v[224:225], v[228:229]
  v_pk_mul_f32 v[226:227], v[226:227], v[230:231]
  v_cvt_pk_bf16_f32 v206, v224, v225
  v_cvt_pk_bf16_f32 v207, v226, v227
  v_max_f32 v232, 0, v232
  v_max_f32 v233, 0, v233
  v_max_f32 v234, 0, v234
  v_max_f32 v235, 0, v235
  v_pk_mul_f32 v[232:233], v[232:233], v[236:237]
  v_pk_mul_f32 v[234:235], v[234:235], v[238:239]
  v_cvt_pk_bf16_f32 v208, v232, v233
  v_cvt_pk_bf16_f32 v209, v234, v235
  v_max_f32 v240, 0, v240
  v_max_f32 v241, 0, v241
  v_max_f32 v242, 0, v242
  v_max_f32 v243, 0, v243
  v_pk_mul_f32 v[240:241], v[240:241], v[244:245]
  v_pk_mul_f32 v[242:243], v[242:243], v[246:247]
  v_cvt_pk_bf16_f32 v210, v240, v241
  v_cvt_pk_bf16_f32 v211, v242, v243
  v_max_f32 v248, 0, v248
  v_max_f32 v249, 0, v249
  v_max_f32 v250, 0, v250
  v_max_f32 v251, 0, v251
  v_pk_mul_f32 v[248:249], v[248:249], v[252:253]
  v_pk_mul_f32 v[250:251], v[250:251], v[254:255]
  v_cvt_pk_bf16_f32 v212, v248, v249
  v_cvt_pk_bf16_f32 v213, v250, v251
  s_bitcmp1_b32 s48, 0
  s_cbranch_scc1 L_hodd2
  buffer_store_dwordx4 v[200:203], v1, s[8:11], s54 offen sc1
  buffer_store_dwordx4 v[204:207], v1, s[8:11], s54 offen offset:1024 sc1
  buffer_store_dwordx4 v[208:211], v1, s[8:11], s54 offen offset:2048 sc1
  buffer_store_dwordx2 v[212:213], v1, s[8:11], s54 offen offset:3072 sc1
  s_branch L_hdone2
L_hodd2:
  buffer_store_dwordx2 v[200:201], v1, s[8:11], s54 offen offset:8 sc1
  buffer_store_dwordx4 v[202:205], v1, s[8:11], s54 offen offset:1024 sc1
  buffer_store_dwordx4 v[206:209], v1, s[8:11], s54 offen offset:2048 sc1
  buffer_store_dwordx4 v[210:213], v1, s[8:11], s54 offen offset:3072 sc1
L_hdone2:
  s_add_u32 s54, s54, 147456
  v_accvgpr_read_b32 v56, a24
  v_accvgpr_read_b32 v57, a25
  v_accvgpr_read_b32 v58, a26
  v_accvgpr_read_b32 v59, a27
  v_accvgpr_read_b32 v60, a28
  v_accvgpr_read_b32 v61, a29
  v_accvgpr_read_b32 v62, a30
  v_accvgpr_read_b32 v63, a31
  v_accvgpr_read_b32 v64, a32
  v_accvgpr_read_b32 v65, a33
  v_accvgpr_read_b32 v66, a34
  v_accvgpr_read_b32 v67, a35
  v_accvgpr_read_b32 v68, a36
  v_accvgpr_read_b32 v69, a37
  v_accvgpr_read_b32 v70, a38
  v_accvgpr_read_b32 v71, a39
  v_accvgpr_read_b32 v72, a40
  v_accvgpr_read_b32 v73, a41
  v_accvgpr_read_b32 v74, a42
  v_accvgpr_read_b32 v75, a43
  v_accvgpr_read_b32 v76, a44
  v_accvgpr_read_b32 v77, a45
  v_accvgpr_read_b32 v78, a46
  v_accvgpr_read_b32 v79, a47
  v_accvgpr_read_b32 v80, a48
  v_accvgpr_read_b32 v81, a49
  v_accvgpr_read_b32 v82, a50
  v_accvgpr_read_b32 v83, a51
  v_accvgpr_read_b32 v84, a52
  v_accvgpr_read_b32 v85, a53
  v_accvgpr_read_b32 v86, a54
  v_accvgpr_read_b32 v87, a55
  v_accvgpr_read_b32 v88, a56
  v_accvgpr_read_b32 v89, a57
  v_accvgpr_read_b32 v90, a58
  v_accvgpr_read_b32 v91, a59
  v_accvgpr_read_b32 v92, a60
  v_accvgpr_read_b32 v93, a61
  v_accvgpr_read_b32 v94, a62
  v_accvgpr_read_b32 v95, a63
  v_accvgpr_read_b32 v136, a64
  v_accvgpr_read_b32 v137, a65
  v_accvgpr_read_b32 v138, a66
  v_accvgpr_read_b32 v139, a67
  v_accvgpr_read_b32 v140, a68
  v_accvgpr_read_b32 v141, a69
  v_accvgpr_read_b32 v142, a70
  v_accvgpr_read_b32 v143, a71
  v_accvgpr_read_b32 v144, a72
  v_accvgpr_read_b32 v145, a73
  v_accvgpr_read_b32 v146, a74
  v_accvgpr_read_b32 v147, a75
  v_accvgpr_read_b32 v148, a76
  v_accvgpr_read_b32 v149, a77
  v_accvgpr_read_b32 v150, a78
  v_accvgpr_read_b32 v151, a79
  v_max_f32 v56, 0, v56
  v_max_f32 v57, 0, v57
  v_max_f32 v58, 0, v58
  v_max_f32 v59, 0, v59
  v_pk_mul_f32 v[56:57], v[56:57], v[60:61]
  v_pk_mul_f32 v[58:59], v[58:59], v[62:63]
  v_cvt_pk_bf16_f32 v40, v56, v57
  v_cvt_pk_bf16_f32 v41, v58, v59
  v_max_f32 v64, 0, v64
  v_max_f32 v65, 0, v65
  v_max_f32 v66, 0, v66
  v_max_f32 v67, 0, v67
  v_pk_mul_f32 v[64:65], v[64:65], v[68:69]
  v_pk_mul_f32 v[66:67], v[66:67], v[70:71]
  v_cvt_pk_bf16_f32 v42, v64, v65
  v_cvt_pk_bf16_f32 v43, v66, v67
  v_max_f32 v72, 0, v72
  v_max_f32 v73, 0, v73
  v_max_f32 v74, 0, v74
  v_max_f32 v75, 0, v75
  v_pk_mul_f32 v[72:73], v[72:73], v[76:77]
  v_pk_mul_f32 v[74:75], v[74:75], v[78:79]
  v_cvt_pk_bf16_f32 v44, v72, v73
  v_cvt_pk_bf16_f32 v45, v74, v75
  v_max_f32 v80, 0, v80
  v_max_f32 v81, 0, v81
  v_max_f32 v82, 0, v82
  v_max_f32 v83, 0, v83
  v_pk_mul_f32 v[80:81], v[80:81], v[84:85]
  v_pk_mul_f32 v[82:83], v[82:83], v[86:87]
  v_cvt_pk_bf16_f32 v46, v80, v81
  v_cvt_pk_bf16_f32 v47, v82, v83
  v_max_f32 v88, 0, v88
  v_max_f32 v89, 0, v89
  v_max_f32 v90, 0, v90
  v_max_f32 v91, 0, v91
  v_pk_mul_f32 v[88:89], v[88:89], v[92:93]
  v_pk_mul_f32 v[90:91], v[90:91], v[94:95]
  v_cvt_pk_bf16_f32 v48, v88, v89
  v_cvt_pk_bf16_f32 v49, v90, v91
  v_max_f32 v136, 0, v136
  v_max_f32 v137, 0, v137
  v_max_f32 v138, 0, v138
  v_max_f32 v139, 0, v139
  v_pk_mul_f32 v[136:137], v[136:137], v[140:141]
  v_pk_mul_f32 v[138:139], v[138:139], v[142:143]
  v_cvt_pk_bf16_f32 v50, v136, v137
  v_cvt_pk_bf16_f32 v51, v138, v139
  v_max_f32 v144, 0, v144
  v_max_f32 v145, 0, v145
  v_max_f32 v146, 0, v146
  v_max_f32 v147, 0, v147
  v_pk_mul_f32 v[144:145], v[144:145], v[148:149]
  v_pk_mul_f32 v[146:147], v[146:147], v[150:151]
  v_cvt_pk_bf16_f32 v52, v144, v145
  v_cvt_pk_bf16_f32 v53, v146, v147
  s_bitcmp1_b32 s48, 0
  s_cbranch_scc1 L_hodd3
  buffer_store_dwordx4 v[40:43], v1, s[8:11], s54 offen sc1
  buffer_store_dwordx4 v[44:47], v1, s[8:11], s54 offen offset:1024 sc1
  buffer_store_dwordx4 v[48:51], v1, s[8:11], s54 offen offset:2048 sc1
  buffer_store_dwordx2 v[52:53], v1, s[8:11], s54 offen offset:3072 sc1
  s_branch L_hdone3
L_hodd3:
  buffer_store_dwordx2 v[40:41], v1, s[8:11], s54 offen offset:8 sc1
  buffer_store_dwordx4 v[42:45], v1, s[8:11], s54 offen offset:1024 sc1
  buffer_store_dwordx4 v[46:49], v1, s[8:11], s54 offen offset:2048 sc1
  buffer_store_dwordx4 v[50:53], v1, s[8:11], s54 offen offset:3072 sc1
L_hdone3:
  s_add_u32 s54, s54, 147456
  v_accvgpr_read_b32 v200, a0
  v_accvgpr_read_b32 v201, a1
  v_accvgpr_read_b32 v202, a2
  v_accvgpr_read_b32 v203, a3
  v_accvgpr_read_b32 v204, a4
  v_accvgpr_read_b32 v205, a5
  v_accvgpr_read_b32 v206, a6
  v_accvgpr_read_b32 v207, a7
  v_accvgpr_read_b32 v208, a8
  v_accvgpr_read_b32 v209, a9
  v_accvgpr_read_b32 v210, a10
  v_accvgpr_read_b32 v211, a11
  v_accvgpr_read_b32 v212, a12
  v_accvgpr_read_b32 v213, a13
  v_accvgpr_read_b32 v214, a14
  v_accvgpr_read_b32 v215, a15
  v_accvgpr_read_b32 v216, a16
  v_accvgpr_read_b32 v217, a17
  v_accvgpr_read_b32 v218, a18
  v_accvgpr_read_b32 v219, a19
  v_accvgpr_read_b32 v220, a20
  v_accvgpr_read_b32 v221, a21
  v_accvgpr_read_b32 v222, a22
  v_accvgpr_read_b32 v223, a23
  v_lshrrev_b32 v10, 4, v0
  v_bfe_u32 v11, v0, 2, 2
  v_and_b32 v12, 3, v0
  v_lshl_add_u32 v13, v10, 2, v11
  v_lshlrev_b32 v13, 6, v13
  v_lshl_add_u32 v13, v12, 3, v13
  v_add_u32 v13, 102400, v13
  ds_read_b64_tr_b16 v[224:225], v13 offset:0
  ds_read_b64_tr_b16 v[226:227], v13 offset:1024
  ds_read_b64_tr_b16 v[228:229], v13 offset:32
  ds_read_b64_tr_b16 v[230:231], v13 offset:1056
  v_and_b32 v12, 15, v0
  v_lshlrev_b32 v11, 2, v10
  v_sub_u32 v12, v12, v11
  v_mov_b32 v14, 0x3f80
  v_mov_b32 v15, 0x3f800000
  v_cmp_eq_u32 vcc, 0, v12
  s_nop 1
  v_cndmask_b32 v232, 0, v14, vcc
  v_cmp_eq_u32 vcc, 1, v12
  s_nop 1
  v_cndmask_b32 v232, v232, v15, vcc
  v_cmp_eq_u32 vcc, 2, v12
  s_nop 1
  v_cndmask_b32 v233, 0, v14, vcc
  v_cmp_eq_u32 vcc, 3, v12
  s_nop 1
  v_cndmask_b32 v233, v233, v15, vcc
  v_mov_b32 v234, 0
  v_mov_b32 v235, 0
  v_mov_b32 v236, 0
  v_mov_b32 v237, 0
  v_mov_b32 v238, v232
  v_mov_b32 v239, v233
  v_mov_b32 v240, 0x3f803f80
  v_mov_b32 v241, 0x3f803f80
  v_mov_b32 v242, 0x3f803f80
  v_mov_b32 v243, 0x3f803f80
  s_mov_b32 s74, 1069066811
  s_mov_b32 s75, 1069066811
  s_mov_b32 s76, 3216550459
  s_mov_b32 s77, 3216550459
  s_waitcnt lgkmcnt(0)
  v_cvt_pk_bf16_f32 v16, v16, v17
  v_cvt_pk_bf16_f32 v17, v18, v19
  v_cvt_pk_bf16_f32 v18, v20, v21
  v_cvt_pk_bf16_f32 v19, v22, v23
  v_cvt_pk_bf16_f32 v96, v96, v97
  v_cvt_pk_bf16_f32 v97, v98, v99
  v_cvt_pk_bf16_f32 v98, v100, v101
  v_cvt_pk_bf16_f32 v99, v102, v103
  v_cvt_pk_bf16_f32 v176, v176, v177
  v_cvt_pk_bf16_f32 v177, v178, v179
  v_cvt_pk_bf16_f32 v178, v180, v181
  v_cvt_pk_bf16_f32 v179, v182, v183
  v_cvt_pk_bf16_f32 v200, v200, v201
  v_cvt_pk_bf16_f32 v201, v202, v203
  v_cvt_pk_bf16_f32 v202, v204, v205
  v_cvt_pk_bf16_f32 v203, v206, v207
  s_nop 0
  v_mfma_f32_16x16x32_bf16 v[40:43], v[224:227], v[16:19], 0
  v_mfma_f32_16x16x32_bf16 v[44:47], v[228:231], v[16:19], 0
  v_mfma_f32_16x16x32_bf16 v[48:51], v[224:227], v[96:99], 0
  v_mfma_f32_16x16x32_bf16 v[52:55], v[228:231], v[96:99], 0
  v_mfma_f32_16x16x32_bf16 v[56:59], v[224:227], v[176:179], 0
  v_mfma_f32_16x16x32_bf16 v[60:63], v[228:231], v[176:179], 0
  v_mfma_f32_16x16x32_bf16 v[64:67], v[224:227], v[200:203], 0
  v_mfma_f32_16x16x32_bf16 v[68:71], v[228:231], v[200:203], 0
  s_nop 1
  s_nop 5
  v_cvt_pk_bf16_f32 v40, v40, v41
  v_cvt_pk_bf16_f32 v41, v42, v43
  v_cvt_pk_bf16_f32 v42, v44, v45
  v_cvt_pk_bf16_f32 v43, v46, v47
  v_cvt_pk_bf16_f32 v48, v48, v49
  v_cvt_pk_bf16_f32 v49, v50, v51
  v_cvt_pk_bf16_f32 v50, v52, v53
  v_cvt_pk_bf16_f32 v51, v54, v55
  v_cvt_pk_bf16_f32 v56, v56, v57
  v_cvt_pk_bf16_f32 v57, v58, v59
  v_cvt_pk_bf16_f32 v58, v60, v61
  v_cvt_pk_bf16_f32 v59, v62, v63
  v_cvt_pk_bf16_f32 v64, v64, v65
  v_cvt_pk_bf16_f32 v65, v66, v67
  v_cvt_pk_bf16_f32 v66, v68, v69
  v_cvt_pk_bf16_f32 v67, v70, v71
  s_add_u32 s12, s62, 25165824
  s_addc_u32 s13, s63, 0
  s_mov_b32 s14, 4194304
  s_mov_b32 s15, 0x00020000
  s_lshl_b32 s53, s48, 17
  s_lshl_b32 s55, s52, 10
  s_add_u32 s53, s53, s55
  buffer_store_dwordx4 v[40:43], v1, s[12:15], s53 offen offset:0
  buffer_store_dwordx4 v[48:51], v1, s[12:15], s53 offen offset:1024
  buffer_store_dwordx4 v[56:59], v1, s[12:15], s53 offen offset:2048
  buffer_store_dwordx4 v[64:67], v1, s[12:15], s53 offen offset:3072
  s_nop 1
  v_cvt_pk_bf16_f32 v24, v24, v25
  v_cvt_pk_bf16_f32 v25, v26, v27
  v_cvt_pk_bf16_f32 v26, v28, v29
  v_cvt_pk_bf16_f32 v27, v30, v31
  v_cvt_pk_bf16_f32 v104, v104, v105
  v_cvt_pk_bf16_f32 v105, v106, v107
  v_cvt_pk_bf16_f32 v106, v108, v109
  v_cvt_pk_bf16_f32 v107, v110, v111
  v_cvt_pk_bf16_f32 v184, v184, v185
  v_cvt_pk_bf16_f32 v185, v186, v187
  v_cvt_pk_bf16_f32 v186, v188, v189
  v_cvt_pk_bf16_f32 v187, v190, v191
  v_cvt_pk_bf16_f32 v208, v208, v209
  v_cvt_pk_bf16_f32 v209, v210, v211
  v_cvt_pk_bf16_f32 v210, v212, v213
  v_cvt_pk_bf16_f32 v211, v214, v215
  s_nop 0
  v_mfma_f32_16x16x32_bf16 v[40:43], v[224:227], v[24:27], 0
  v_mfma_f32_16x16x32_bf16 v[44:47], v[228:231], v[24:27], 0
  v_mfma_f32_16x16x32_bf16 v[48:51], v[224:227], v[104:107], 0
  v_mfma_f32_16x16x32_bf16 v[52:55], v[228:231], v[104:107], 0
  v_mfma_f32_16x16x32_bf16 v[56:59], v[224:227], v[184:187], 0
  v_mfma_f32_16x16x32_bf16 v[60:63], v[228:231], v[184:187], 0
  v_mfma_f32_16x16x32_bf16 v[64:67], v[224:227], v[208:211], 0
  v_mfma_f32_16x16x32_bf16 v[68:71], v[228:231], v[208:211], 0
  s_nop 1
  s_nop 1
  v_max3_f32 v72, v40, v41, v42
  v_max3_f32 v73, -v40, -v41, -v42
  v_max3_f32 v72, v72, v43, v43
  v_max3_f32 v73, v73, -v43, -v43
  s_nop 1
  v_max3_f32 v76, v48, v49, v50
  v_max3_f32 v77, -v48, -v49, -v50
  v_max3_f32 v76, v76, v51, v51
  v_max3_f32 v77, v77, -v51, -v51
  v_max3_f32 v80, v56, v57, v58
  v_max3_f32 v81, -v56, -v57, -v58
  v_max3_f32 v80, v80, v59, v59
  v_max3_f32 v81, v81, -v59, -v59
  v_max3_f32 v84, v64, v65, v66
  v_max3_f32 v85, -v64, -v65, -v66
  v_max3_f32 v84, v84, v67, v67
  v_max3_f32 v85, v85, -v67, -v67
  v_max3_f32 v72, v72, v44, v45
  v_max3_f32 v73, v73, -v44, -v45
  v_max3_f32 v72, v72, v46, v47
  v_max3_f32 v73, v73, -v46, -v47
  v_max3_f32 v76, v76, v52, v53
  v_max3_f32 v77, v77, -v52, -v53
  v_max3_f32 v76, v76, v54, v55
  v_max3_f32 v77, v77, -v54, -v55
  v_max3_f32 v80, v80, v60, v61
  v_max3_f32 v81, v81, -v60, -v61
  v_max3_f32 v80, v80, v62, v63
  v_max3_f32 v81, v81, -v62, -v63
  v_max3_f32 v84, v84, v68, v69
  v_max3_f32 v85, v85, -v68, -v69
  v_max3_f32 v84, v84, v70, v71
  v_max3_f32 v85, v85, -v70, -v71
  v_permlane16_swap_b32 v72, v73
  v_permlane16_swap_b32 v76, v77
  v_permlane16_swap_b32 v80, v81
  v_permlane16_swap_b32 v84, v85
  v_max_f32 v72, v72, v73
  v_mov_b32 v74, v72
  v_max_f32 v76, v76, v77
  v_mov_b32 v78, v76
  v_max_f32 v80, v80, v81
  v_mov_b32 v82, v80
  v_max_f32 v84, v84, v85
  v_mov_b32 v86, v84
  v_permlane32_swap_b32 v72, v74
  v_permlane32_swap_b32 v76, v78
  v_permlane32_swap_b32 v80, v82
  s_nop 0
  v_permlane32_swap_b32 v84, v86
  v_max_f32 v72, v72, v74
  v_mov_b32 v74, v72
  v_max_f32 v76, v76, v78
  v_mov_b32 v78, v76
  v_max_f32 v80, v80, v82
  v_mov_b32 v82, v80
  v_max_f32 v84, v84, v86
  v_mov_b32 v86, v84
  v_permlane16_swap_b32 v72, v74
  v_permlane16_swap_b32 v76, v78
  v_permlane16_swap_b32 v80, v82
  s_nop 0
  v_permlane16_swap_b32 v84, v86
  v_mul_f32 v72, s76, v72
  v_mul_f32 v74, s76, v74
  v_mul_f32 v76, s76, v76
  v_mul_f32 v78, s76, v78
  v_mul_f32 v80, s76, v80
  v_mul_f32 v82, s76, v82
  v_mul_f32 v84, s76, v84
  v_mul_f32 v86, s76, v86
  v_pk_fma_f32 v[120:121], v[40:41], s[76:77], v[74:75] op_sel_hi:[1,1,0]
  v_pk_fma_f32 v[122:123], v[42:43], s[76:77], v[74:75] op_sel_hi:[1,1,0]
  v_pk_fma_f32 v[124:125], v[44:45], s[76:77], v[74:75] op_sel_hi:[1,1,0]
  v_pk_fma_f32 v[126:127], v[46:47], s[76:77], v[74:75] op_sel_hi:[1,1,0]
  v_pk_fma_f32 v[40:41], v[40:41], s[74:75], v[72:73] op_sel_hi:[1,1,0]
  v_pk_fma_f32 v[42:43], v[42:43], s[74:75], v[72:73] op_sel_hi:[1,1,0]
  v_pk_fma_f32 v[44:45], v[44:45], s[74:75], v[72:73] op_sel_hi:[1,1,0]
  v_pk_fma_f32 v[46:47], v[46:47], s[74:75], v[72:73] op_sel_hi:[1,1,0]
  v_pk_fma_f32 v[128:129], v[48:49], s[76:77], v[78:79] op_sel_hi:[1,1,0]
  v_pk_fma_f32 v[130:131], v[50:51], s[76:77], v[78:79] op_sel_hi:[1,1,0]
  v_pk_fma_f32 v[132:133], v[52:53], s[76:77], v[78:79] op_sel_hi:[1,1,0]
  v_pk_fma_f32 v[134:135], v[54:55], s[76:77], v[78:79] op_sel_hi:[1,1,0]
  v_pk_fma_f32 v[48:49], v[48:49], s[74:75], v[76:77] op_sel_hi:[1,1,0]
  v_pk_fma_f32 v[50:51], v[50:51], s[74:75], v[76:77] op_sel_hi:[1,1,0]
  v_pk_fma_f32 v[52:53], v[52:53], s[74:75], v[76:77] op_sel_hi:[1,1,0]
  v_pk_fma_f32 v[54:55], v[54:55], s[74:75], v[76:77] op_sel_hi:[1,1,0]
  v_pk_fma_f32 v[136:137], v[56:57], s[76:77], v[82:83] op_sel_hi:[1,1,0]
  v_pk_fma_f32 v[138:139], v[58:59], s[76:77], v[82:83] op_sel_hi:[1,1,0]
  v_pk_fma_f32 v[140:141], v[60:61], s[76:77], v[82:83] op_sel_hi:[1,1,0]
  v_pk_fma_f32 v[142:143], v[62:63], s[76:77], v[82:83] op_sel_hi:[1,1,0]
  v_pk_fma_f32 v[56:57], v[56:57], s[74:75], v[80:81] op_sel_hi:[1,1,0]
  v_pk_fma_f32 v[58:59], v[58:59], s[74:75], v[80:81] op_sel_hi:[1,1,0]
  v_pk_fma_f32 v[60:61], v[60:61], s[74:75], v[80:81] op_sel_hi:[1,1,0]
  v_pk_fma_f32 v[62:63], v[62:63], s[74:75], v[80:81] op_sel_hi:[1,1,0]
  v_pk_fma_f32 v[144:145], v[64:65], s[76:77], v[86:87] op_sel_hi:[1,1,0]
  v_pk_fma_f32 v[146:147], v[66:67], s[76:77], v[86:87] op_sel_hi:[1,1,0]
  v_pk_fma_f32 v[148:149], v[68:69], s[76:77], v[86:87] op_sel_hi:[1,1,0]
  v_pk_fma_f32 v[150:151], v[70:71], s[76:77], v[86:87] op_sel_hi:[1,1,0]
  v_pk_fma_f32 v[64:65], v[64:65], s[74:75], v[84:85] op_sel_hi:[1,1,0]
  v_pk_fma_f32 v[66:67], v[66:67], s[74:75], v[84:85] op_sel_hi:[1,1,0]
  v_pk_fma_f32 v[68:69], v[68:69], s[74:75], v[84:85] op_sel_hi:[1,1,0]
  v_pk_fma_f32 v[70:71], v[70:71], s[74:75], v[84:85] op_sel_hi:[1,1,0]
  v_exp_f32 v40, v40
  v_exp_f32 v120, v120
  v_exp_f32 v41, v41
  v_exp_f32 v121, v121
  v_exp_f32 v42, v42
  v_exp_f32 v122, v122
  v_exp_f32 v43, v43
  v_exp_f32 v123, v123
  v_exp_f32 v44, v44
  v_exp_f32 v124, v124
  v_exp_f32 v45, v45
  v_exp_f32 v125, v125
  v_exp_f32 v46, v46
  v_exp_f32 v126, v126
  v_exp_f32 v47, v47
  v_exp_f32 v127, v127
  v_exp_f32 v48, v48
  v_exp_f32 v128, v128
  v_exp_f32 v49, v49
  v_exp_f32 v129, v129
  v_exp_f32 v50, v50
  v_exp_f32 v130, v130
  v_exp_f32 v51, v51
  v_exp_f32 v131, v131
  v_exp_f32 v52, v52
  v_exp_f32 v132, v132
  v_exp_f32 v53, v53
  v_exp_f32 v133, v133
  v_exp_f32 v54, v54
  v_exp_f32 v134, v134
  v_exp_f32 v55, v55
  v_exp_f32 v135, v135
  v_exp_f32 v56, v56
  v_exp_f32 v136, v136
  v_exp_f32 v57, v57
  v_exp_f32 v137, v137
  v_exp_f32 v58, v58
  v_exp_f32 v138, v138
  v_exp_f32 v59, v59
  v_exp_f32 v139, v139
  v_exp_f32 v60, v60
  v_exp_f32 v140, v140
  v_exp_f32 v61, v61
  v_exp_f32 v141, v141
  v_exp_f32 v62, v62
  v_exp_f32 v142, v142
  v_exp_f32 v63, v63
  v_exp_f32 v143, v143
  v_exp_f32 v64, v64
  v_exp_f32 v144, v144
  v_exp_f32 v65, v65
  v_exp_f32 v145, v145
  v_exp_f32 v66, v66
  v_exp_f32 v146, v146
  v_exp_f32 v67, v67
  v_exp_f32 v147, v147
  v_exp_f32 v68, v68
  v_exp_f32 v148, v148
  v_exp_f32 v69, v69
  v_exp_f32 v149, v149
  v_exp_f32 v70, v70
  v_exp_f32 v150, v150
  v_exp_f32 v71, v71
  v_exp_f32 v151, v151
  v_cvt_pk_bf16_f32 v40, v40, v41
  v_cvt_pk_bf16_f32 v41, v42, v43
  v_cvt_pk_bf16_f32 v42, v44, v45
  v_cvt_pk_bf16_f32 v43, v46, v47
  v_cvt_pk_bf16_f32 v120, v120, v121
  v_cvt_pk_bf16_f32 v121, v122, v123
  v_cvt_pk_bf16_f32 v122, v124, v125
  v_cvt_pk_bf16_f32 v123, v126, v127
  v_cvt_pk_bf16_f32 v48, v48, v49
  v_cvt_pk_bf16_f32 v49, v50, v51
  v_cvt_pk_bf16_f32 v50, v52, v53
  v_cvt_pk_bf16_f32 v51, v54, v55
  v_cvt_pk_bf16_f32 v128, v128, v129
  v_cvt_pk_bf16_f32 v129, v130, v131
  v_cvt_pk_bf16_f32 v130, v132, v133
  v_cvt_pk_bf16_f32 v131, v134, v135
  v_cvt_pk_bf16_f32 v56, v56, v57
  v_cvt_pk_bf16_f32 v57, v58, v59
  v_cvt_pk_bf16_f32 v58, v60, v61
  v_cvt_pk_bf16_f32 v59, v62, v63
  v_cvt_pk_bf16_f32 v136, v136, v137
  v_cvt_pk_bf16_f32 v137, v138, v139
  v_cvt_pk_bf16_f32 v138, v140, v141
  v_cvt_pk_bf16_f32 v139, v142, v143
  v_cvt_pk_bf16_f32 v64, v64, v65
  v_cvt_pk_bf16_f32 v65, v66, v67
  v_cvt_pk_bf16_f32 v66, v68, v69
  v_cvt_pk_bf16_f32 v67, v70, v71
  v_cvt_pk_bf16_f32 v144, v144, v145
  v_cvt_pk_bf16_f32 v145, v146, v147
  v_cvt_pk_bf16_f32 v146, v148, v149
  v_cvt_pk_bf16_f32 v147, v150, v151
  v_mfma_f32_16x16x32_bf16 v[80:83], v[40:43], v[240:243], 0
  v_mfma_f32_16x16x32_bf16 v[72:75], v[40:43], v[232:235], 0
  v_mfma_f32_16x16x32_bf16 v[76:79], v[40:43], v[236:239], 0
  v_mfma_f32_16x16x32_bf16 v[92:95], v[120:123], v[240:243], 0
  v_mfma_f32_16x16x32_bf16 v[84:87], v[120:123], v[232:235], 0
  v_mfma_f32_16x16x32_bf16 v[88:91], v[120:123], v[236:239], 0
  v_mfma_f32_16x16x32_bf16 v[160:163], v[48:51], v[240:243], 0
  v_mfma_f32_16x16x32_bf16 v[152:155], v[48:51], v[232:235], 0
  v_mfma_f32_16x16x32_bf16 v[156:159], v[48:51], v[236:239], 0
  v_mfma_f32_16x16x32_bf16 v[172:175], v[128:131], v[240:243], 0
  v_mfma_f32_16x16x32_bf16 v[164:167], v[128:131], v[232:235], 0
  v_mfma_f32_16x16x32_bf16 v[168:171], v[128:131], v[236:239], 0
  v_cvt_pk_bf16_f32 v244, v32, v33
  v_cvt_pk_bf16_f32 v245, v34, v35
  v_cvt_pk_bf16_f32 v246, v112, v113
  v_cvt_pk_bf16_f32 v247, v114, v115
  v_cvt_pk_bf16_f32 v248, v36, v37
  v_cvt_pk_bf16_f32 v249, v38, v39
  v_cvt_pk_bf16_f32 v250, v116, v117
  v_cvt_pk_bf16_f32 v251, v118, v119
  v_rcp_f32 v80, v80
  v_rcp_f32 v81, v81
  v_rcp_f32 v82, v82
  v_rcp_f32 v83, v83
  v_rcp_f32 v92, v92
  v_rcp_f32 v93, v93
  v_rcp_f32 v94, v94
  v_rcp_f32 v95, v95
  v_rcp_f32 v160, v160
  v_rcp_f32 v161, v161
  v_rcp_f32 v162, v162
  v_rcp_f32 v163, v163
  v_rcp_f32 v172, v172
  v_rcp_f32 v173, v173
  v_rcp_f32 v174, v174
  v_rcp_f32 v175, v175
  s_nop 0
  v_pk_mul_f32 v[72:73], v[72:73], v[80:81]
  v_pk_mul_f32 v[74:75], v[74:75], v[82:83]
  v_pk_mul_f32 v[76:77], v[76:77], v[80:81]
  v_pk_mul_f32 v[78:79], v[78:79], v[82:83]
  v_pk_mul_f32 v[84:85], v[84:85], v[92:93]
  v_pk_mul_f32 v[86:87], v[86:87], v[94:95]
  v_pk_mul_f32 v[88:89], v[88:89], v[92:93]
  v_pk_mul_f32 v[90:91], v[90:91], v[94:95]
  v_pk_mul_f32 v[152:153], v[152:153], v[160:161]
  v_pk_mul_f32 v[154:155], v[154:155], v[162:163]
  v_pk_mul_f32 v[156:157], v[156:157], v[160:161]
  v_pk_mul_f32 v[158:159], v[158:159], v[162:163]
  v_pk_mul_f32 v[164:165], v[164:165], v[172:173]
  v_pk_mul_f32 v[166:167], v[166:167], v[174:175]
  v_pk_mul_f32 v[168:169], v[168:169], v[172:173]
  v_pk_mul_f32 v[170:171], v[170:171], v[174:175]
  v_cvt_pk_bf16_f32 v40, v72, v73
  v_cvt_pk_bf16_f32 v41, v74, v75
  v_cvt_pk_bf16_f32 v44, v76, v77
  v_cvt_pk_bf16_f32 v45, v78, v79
  v_cvt_pk_bf16_f32 v48, v84, v85
  v_cvt_pk_bf16_f32 v49, v86, v87
  v_cvt_pk_bf16_f32 v52, v88, v89
  v_cvt_pk_bf16_f32 v53, v90, v91
  v_cvt_pk_bf16_f32 v42, v152, v153
  v_cvt_pk_bf16_f32 v43, v154, v155
  v_cvt_pk_bf16_f32 v46, v156, v157
  v_cvt_pk_bf16_f32 v47, v158, v159
  v_cvt_pk_bf16_f32 v50, v164, v165
  v_cvt_pk_bf16_f32 v51, v166, v167
  v_cvt_pk_bf16_f32 v54, v168, v169
  v_cvt_pk_bf16_f32 v55, v170, v171
  s_nop 1
  v_mfma_f32_16x16x32_bf16 v[16:19], v[40:43], v[244:247], 0
  v_mfma_f32_16x16x32_bf16 v[20:23], v[40:43], v[248:251], 0
  v_mfma_f32_16x16x32_bf16 v[176:179], v[40:43], v[240:243], 0
  v_mfma_f32_16x16x32_bf16 v[24:27], v[44:47], v[244:247], 0
  v_mfma_f32_16x16x32_bf16 v[28:31], v[44:47], v[248:251], 0
  v_mfma_f32_16x16x32_bf16 v[180:183], v[44:47], v[240:243], 0
  v_mfma_f32_16x16x32_bf16 v[96:99], v[48:51], v[244:247], 0
  v_mfma_f32_16x16x32_bf16 v[100:103], v[48:51], v[248:251], 0
  v_mfma_f32_16x16x32_bf16 v[184:187], v[48:51], v[240:243], 0
  v_mfma_f32_16x16x32_bf16 v[104:107], v[52:55], v[244:247], 0
  v_mfma_f32_16x16x32_bf16 v[108:111], v[52:55], v[248:251], 0
  v_mfma_f32_16x16x32_bf16 v[188:191], v[52:55], v[240:243], 0
  v_mfma_f32_16x16x32_bf16 v[80:83], v[56:59], v[240:243], 0
  v_mfma_f32_16x16x32_bf16 v[72:75], v[56:59], v[232:235], 0
  v_mfma_f32_16x16x32_bf16 v[76:79], v[56:59], v[236:239], 0
  v_mfma_f32_16x16x32_bf16 v[92:95], v[136:139], v[240:243], 0
  v_mfma_f32_16x16x32_bf16 v[84:87], v[136:139], v[232:235], 0
  v_mfma_f32_16x16x32_bf16 v[88:91], v[136:139], v[236:239], 0
  v_mfma_f32_16x16x32_bf16 v[160:163], v[64:67], v[240:243], 0
  v_mfma_f32_16x16x32_bf16 v[152:155], v[64:67], v[232:235], 0
  v_mfma_f32_16x16x32_bf16 v[156:159], v[64:67], v[236:239], 0
  v_mfma_f32_16x16x32_bf16 v[172:175], v[144:147], v[240:243], 0
  v_mfma_f32_16x16x32_bf16 v[164:167], v[144:147], v[232:235], 0
  v_mfma_f32_16x16x32_bf16 v[168:171], v[144:147], v[236:239], 0
  v_cvt_pk_bf16_f32 v244, v192, v193
  v_cvt_pk_bf16_f32 v245, v194, v195
  v_cvt_pk_bf16_f32 v246, v216, v217
  v_cvt_pk_bf16_f32 v247, v218, v219
  v_cvt_pk_bf16_f32 v248, v196, v197
  v_cvt_pk_bf16_f32 v249, v198, v199
  v_cvt_pk_bf16_f32 v250, v220, v221
  v_cvt_pk_bf16_f32 v251, v222, v223
  v_rcp_f32 v80, v80
  v_rcp_f32 v81, v81
  v_rcp_f32 v82, v82
  v_rcp_f32 v83, v83
  v_rcp_f32 v92, v92
  v_rcp_f32 v93, v93
  v_rcp_f32 v94, v94
  v_rcp_f32 v95, v95
  v_rcp_f32 v160, v160
  v_rcp_f32 v161, v161
  v_rcp_f32 v162, v162
  v_rcp_f32 v163, v163
  v_rcp_f32 v172, v172
  v_rcp_f32 v173, v173
  v_rcp_f32 v174, v174
  v_rcp_f32 v175, v175
  s_nop 0
  v_pk_mul_f32 v[72:73], v[72:73], v[80:81]
  v_pk_mul_f32 v[74:75], v[74:75], v[82:83]
  v_pk_mul_f32 v[76:77], v[76:77], v[80:81]
  v_pk_mul_f32 v[78:79], v[78:79], v[82:83]
  v_pk_mul_f32 v[84:85], v[84:85], v[92:93]
  v_pk_mul_f32 v[86:87], v[86:87], v[94:95]
  v_pk_mul_f32 v[88:89], v[88:89], v[92:93]
  v_pk_mul_f32 v[90:91], v[90:91], v[94:95]
  v_pk_mul_f32 v[152:153], v[152:153], v[160:161]
  v_pk_mul_f32 v[154:155], v[154:155], v[162:163]
  v_pk_mul_f32 v[156:157], v[156:157], v[160:161]
  v_pk_mul_f32 v[158:159], v[158:159], v[162:163]
  v_pk_mul_f32 v[164:165], v[164:165], v[172:173]
  v_pk_mul_f32 v[166:167], v[166:167], v[174:175]
  v_pk_mul_f32 v[168:169], v[168:169], v[172:173]
  v_pk_mul_f32 v[170:171], v[170:171], v[174:175]
  v_cvt_pk_bf16_f32 v56, v72, v73
  v_cvt_pk_bf16_f32 v57, v74, v75
  v_cvt_pk_bf16_f32 v60, v76, v77
  v_cvt_pk_bf16_f32 v61, v78, v79
  v_cvt_pk_bf16_f32 v64, v84, v85
  v_cvt_pk_bf16_f32 v65, v86, v87
  v_cvt_pk_bf16_f32 v68, v88, v89
  v_cvt_pk_bf16_f32 v69, v90, v91
  v_cvt_pk_bf16_f32 v58, v152, v153
  v_cvt_pk_bf16_f32 v59, v154, v155
  v_cvt_pk_bf16_f32 v62, v156, v157
  v_cvt_pk_bf16_f32 v63, v158, v159
  v_cvt_pk_bf16_f32 v66, v164, v165
  v_cvt_pk_bf16_f32 v67, v166, v167
  v_cvt_pk_bf16_f32 v70, v168, v169
  v_cvt_pk_bf16_f32 v71, v170, v171
  s_nop 1
  v_mfma_f32_16x16x32_bf16 v[16:19], v[56:59], v[244:247], v[16:19]
  v_mfma_f32_16x16x32_bf16 v[20:23], v[56:59], v[248:251], v[20:23]
  v_mfma_f32_16x16x32_bf16 v[176:179], v[56:59], v[240:243], v[176:179]
  v_mfma_f32_16x16x32_bf16 v[24:27], v[60:63], v[244:247], v[24:27]
  v_mfma_f32_16x16x32_bf16 v[28:31], v[60:63], v[248:251], v[28:31]
  v_mfma_f32_16x16x32_bf16 v[180:183], v[60:63], v[240:243], v[180:183]
  v_mfma_f32_16x16x32_bf16 v[96:99], v[64:67], v[244:247], v[96:99]
  v_mfma_f32_16x16x32_bf16 v[100:103], v[64:67], v[248:251], v[100:103]
  v_mfma_f32_16x16x32_bf16 v[184:187], v[64:67], v[240:243], v[184:187]
  v_mfma_f32_16x16x32_bf16 v[104:107], v[68:71], v[244:247], v[104:107]
  v_mfma_f32_16x16x32_bf16 v[108:111], v[68:71], v[248:251], v[108:111]
  v_mfma_f32_16x16x32_bf16 v[188:191], v[68:71], v[240:243], v[188:191]
  s_nop 7
  s_mul_i32 s53, s47, 12288
  v_add_u32 v10, s53, v1
  ds_write_b128 v10, v[16:19] offset:0
  ds_write_b128 v10, v[20:23] offset:1024
  ds_write_b128 v10, v[24:27] offset:2048
  ds_write_b128 v10, v[28:31] offset:3072
  ds_write_b128 v10, v[96:99] offset:4096
  ds_write_b128 v10, v[100:103] offset:5120
  ds_write_b128 v10, v[104:107] offset:6144
  ds_write_b128 v10, v[108:111] offset:7168
  ds_write_b128 v10, v[176:179] offset:8192
  ds_write_b128 v10, v[180:183] offset:9216
  ds_write_b128 v10, v[184:187] offset:10240
  ds_write_b128 v10, v[188:191] offset:11264
  s_waitcnt lgkmcnt(0)
  s_barrier
  s_lshr_b32 s53, s47, 1
  s_lshl_b32 s53, s53, 2
  s_and_b32 s55, s47, 1
  s_add_u32 s53, s53, s55
  s_lshl_b32 s53, s53, 10
  v_add_u32 v10, s53, v1
  s_add_u32 s53, s47, 8
  s_lshl_b32 s53, s53, 10
  v_add_u32 v11, s53, v1
  ds_read_b128 v[40:43], v10 offset:0
  ds_read_b128 v[44:47], v10 offset:2048
  ds_read_b128 v[48:51], v11 offset:0
  ds_read_b128 v[52:55], v10 offset:12288
  ds_read_b128 v[56:59], v10 offset:14336
  ds_read_b128 v[60:63], v11 offset:12288
  ds_read_b128 v[64:67], v10 offset:24576
  ds_read_b128 v[68:71], v10 offset:26624
  ds_read_b128 v[72:75], v11 offset:24576
  ds_read_b128 v[76:79], v10 offset:36864
  ds_read_b128 v[80:83], v10 offset:38912
  ds_read_b128 v[84:87], v11 offset:36864
  s_lshl_b32 s53, s48, 3
  s_add_u32 s53, s53, s49
  s_add_u32 s8, s62, 33554432
  s_addc_u32 s9, s63, 0
  s_mov_b32 s10, 1048576
  s_mov_b32 s11, 0x00020000
  s_add_u32 s12, s62, 36700160
  s_addc_u32 s13, s63, 0
  s_mov_b32 s14, 65536
  s_mov_b32 s15, 0x00020000
  s_lshl_b32 s55, s53, 12
  s_lshl_b32 s56, s47, 10
  s_add_u32 s55, s55, s56
  s_lshl_b32 s56, s53, 8
  s_lshl_b32 s57, s47, 6
  s_add_u32 s56, s56, s57
  v_lshrrev_b32 v12, 4, v0
  v_lshlrev_b32 v12, 4, v12
  s_waitcnt lgkmcnt(0)
  v_pk_add_f32 v[40:41], v[40:41], v[52:53]
  v_pk_add_f32 v[64:65], v[64:65], v[76:77]
  v_pk_add_f32 v[42:43], v[42:43], v[54:55]
  v_pk_add_f32 v[66:67], v[66:67], v[78:79]
  v_pk_add_f32 v[44:45], v[44:45], v[56:57]
  v_pk_add_f32 v[68:69], v[68:69], v[80:81]
  v_pk_add_f32 v[46:47], v[46:47], v[58:59]
  v_pk_add_f32 v[70:71], v[70:71], v[82:83]
  v_pk_add_f32 v[48:49], v[48:49], v[60:61]
  v_pk_add_f32 v[72:73], v[72:73], v[84:85]
  v_pk_add_f32 v[50:51], v[50:51], v[62:63]
  v_pk_add_f32 v[74:75], v[74:75], v[86:87]
  v_pk_add_f32 v[40:41], v[40:41], v[64:65]
  v_pk_add_f32 v[42:43], v[42:43], v[66:67]
  v_pk_add_f32 v[44:45], v[44:45], v[68:69]
  v_pk_add_f32 v[46:47], v[46:47], v[70:71]
  v_pk_add_f32 v[48:49], v[48:49], v[72:73]
  v_pk_add_f32 v[50:51], v[50:51], v[74:75]
  v_cvt_pk_bf16_f32 v40, v40, v41
  v_cvt_pk_bf16_f32 v41, v42, v43
  v_cvt_pk_bf16_f32 v42, v44, v45
  v_cvt_pk_bf16_f32 v43, v46, v47
  buffer_store_dwordx4 v[40:43], v1, s[8:11], s55 offen
  s_mov_b32 exec_lo, 0x00010001
  s_mov_b32 exec_hi, 0x00010001
  buffer_store_dwordx4 v[48:51], v12, s[12:15], s56 offen
  s_mov_b64 exec, -1
L_k2_end:
  s_endpgm

.globl k3_gemm2_kernel
.p2align 8
.type k3_gemm2_kernel,@function
k3_gemm2_kernel:
  s_cmp_ge_u32 s2, 512
  s_cbranch_scc1 L_k3_end
  s_load_dwordx2 s[4:5], s[0:1], 56
  s_load_dwordx2 s[6:7], s[0:1], 80
  s_load_dwordx2 s[26:27], s[0:1], 24
  s_load_dwordx2 s[68:69], s[0:1], 0
  s_load_dwordx2 s[44:45], s[0:1], 64
  v_lshrrev_b32 v11, 6, v0
  v_and_b32 v0, 63, v0
  v_lshlrev_b32 v1, 4, v0
  v_readfirstlane_b32 s23, v11
  s_and_b32 s50, s2, 7
  s_lshr_b32 s51, s2, 3
  s_and_b32 s33, s50, 1
  s_lshr_b32 s52, s50, 1
  s_lshl_b32 s52, s52, 2
  s_lshr_b32 s53, s51, 3
  s_add_u32 s31, s52, s53
  s_and_b32 s32, s51, 7
  v_lshrrev_b32 v11, 4, v0
  v_bfe_u32 v12, v0, 1, 3
  v_xor_b32 v12, v12, v11
  v_xor_b32 v13, 4, v12
  v_and_b32 v14, 1, v0
  v_lshlrev_b32 v14, 4, v14
  v_lshl_add_u32 v14, v11, 11, v14
  v_lshl_add_u32 v12, v12, 5, v14
  v_lshl_add_u32 v13, v13, 5, v14
  s_lshl_b32 s54, s32, 8
  s_lshl_b32 s55, s23, 15
  s_add_u32 s54, s54, s55
  v_add_u32 v2, s54, v12
  v_add_u32 v3, s54, v13
  v_add_u32 v3, 7168, v3
  v_add_u32 v4, 14336, v2
  v_add_u32 v5, 14336, v3
  s_lshl_b32 s54, s31, 3
  s_lshl_b32 s55, s23, 1
  s_add_u32 s54, s54, s55
  s_mul_i32 s55, s54, 147456
  v_add_u32 v6, s55, v1
  v_add_u32 v7, 147456, v6
  s_and_b32 s56, s31, 3
  s_lshl_b32 s56, s56, 1
  s_add_u32 s55, s32, s56
  s_and_b32 s57, s55, 7
  s_cmp_ge_u32 s55, 7
  s_cselect_b32 s56, 7, 0
  s_sub_u32 s55, s55, s56
  s_add_u32 s56, s32, s31
  v_subrev_u32 v12, s56, v0
  v_and_b32 v12, 3, v12
  v_add_u32 v11, 24, v0
  v_subrev_u32 v13, 28, v11
  v_cmp_le_u32 vcc, 28, v11
  s_nop 1
  v_cndmask_b32 v11, v11, v13, vcc
  v_cmp_gt_u32 vcc, 1, v12
  s_nop 1
  v_cndmask_b32 v11, v11, v0, vcc
  v_subrev_u32 v12, 28, v0
  v_add_u32 v13, 4, v12
  v_and_b32 v13, 7, v13
  v_and_b32 v12, 7, v12
  v_cndmask_b32 v12, v13, v12, vcc
  s_mul_i32 s73, s33, 57344
  s_add_u32 s73, s73, 32768
  s_lshl_b32 s74, s33, 14
  v_lshlrev_b32 v13, 11, v11
  v_add_u32 v13, s73, v13
  v_lshlrev_b32 v14, 11, v12
  v_add_u32 v14, s74, v14
  v_cmp_le_u32 vcc, 28, v0
  s_nop 1
  v_cndmask_b32 v21, v13, v14, vcc
  v_cndmask_b32 v11, v11, v12, vcc
  v_lshlrev_b32 v20, 17, v11
  v_cmp_le_u32 vcc, 36, v0
  v_mov_b32 v11, 0x40000000
  s_nop 0
  v_cndmask_b32 v21, v21, v11, vcc
  v_cndmask_b32 v20, v20, v11, vcc
  s_mov_b32 s40, 0
  s_lshl_b32 s41, s23, 12
  s_waitcnt lgkmcnt(0)
  s_mul_i32 s55, s33, 3670016
  s_add_u32 s4, s4, s55
  s_addc_u32 s5, s5, 0
  s_lshl_b32 s55, s33, 20
  s_add_u32 s26, s26, s55
  s_addc_u32 s27, s27, 0
  s_mov_b32 s29, 3670016
  s_mov_b32 s28, 1048576
  s_mov_b32 s15, 0x00020000
  s_add_u32 s8, s6, 4194304
  s_addc_u32 s9, s7, 0
  s_mov_b32 s10, 18874368
  s_mov_b32 s11, 0x00020000
  s_add_u32 s36, s6, 37781504
  s_addc_u32 s37, s7, 0
  s_mov_b32 s38, 8192
  s_mov_b32 s39, 0x00020000
  s_cmp_ge_u32 s2, 256
  s_cbranch_scc1 L_k3_helper
  s_mov_b32 s12, s4
  s_mov_b32 s13, s5
  s_mov_b32 s14, s29
  v_readlane_b32 s16, v20, s40
  v_readlane_b32 s17, v21, s40
  s_add_u32 s40, s40, 1
  s_add_u32 m0, s41, 0
  s_nop 2
  buffer_load_dwordx4 v2, s[12:15], s16 offen offset:0 lds
  buffer_load_dwordx4 v3, s[12:15], s16 offen offset:1024 lds
  buffer_load_dwordx4 v4, s[12:15], s16 offen offset:2048 lds
  buffer_load_dwordx4 v5, s[12:15], s16 offen offset:3072 lds
  buffer_load_dwordx4 a[0:3], v6, s[8:11], s17 offen offset:0 sc1
  buffer_load_dwordx4 a[4:7], v6, s[8:11], s17 offen offset:1024 sc1
  buffer_load_dwordx4 a[8:11], v7, s[8:11], s17 offen offset:0 sc1
  buffer_load_dwordx4 a[12:15], v7, s[8:11], s17 offen offset:1024 sc1
  v_readlane_b32 s16, v20, s40
  v_readlane_b32 s17, v21, s40
  s_add_u32 s40, s40, 1
  s_add_u32 m0, s41, 16384
  s_nop 2
  buffer_load_dwordx4 v2, s[12:15], s16 offen offset:0 lds
  buffer_load_dwordx4 v3, s[12:15], s16 offen offset:1024 lds
  buffer_load_dwordx4 v4, s[12:15], s16 offen offset:2048 lds
  buffer_load_dwordx4 v5, s[12:15], s16 offen offset:3072 lds
  buffer_load_dwordx4 a[16:19], v6, s[8:11], s17 offen offset:0 sc1
  buffer_load_dwordx4 a[20:23], v6, s[8:11], s17 offen offset:1024 sc1
  buffer_load_dwordx4 a[24:27], v7, s[8:11], s17 offen offset:0 sc1
  buffer_load_dwordx4 a[28:31], v7, s[8:11], s17 offen offset:1024 sc1
  s_mov_b32 s46, 4194304
  s_mov_b32 s47, 0x00020000
  s_mov_b32 s70, 4194304
  s_mov_b32 s71, 0x00020000
  v_lshrrev_b32 v11, 3, v0
  v_lshlrev_b32 v11, 11, v11
  v_and_b32 v12, 7, v0
  v_lshl_add_u32 v11, v12, 4, v11
  s_lshl_b32 s55, s54, 15
  s_lshl_b32 s56, s32, 8
  s_add_u32 s55, s55, s56
  s_lshl_b32 s56, s33, 7
  s_add_u32 s55, s55, s56
  v_add_u32 v9, s55, v11
  s_mov_b32 s92, 0
  s_mov_b32 s93, 16384
  s_mov_b32 s94, 32768
  s_mov_b32 s95, 49152
  v_lshrrev_b32 v11, 4, v0
  v_bfe_u32 v12, v0, 2, 2
  v_lshl_add_u32 v11, v11, 2, v12
  v_and_b32 v12, 7, v11
  v_lshlrev_b32 v12, 5, v12
  v_and_b32 v13, 3, v0
  v_lshlrev_b32 v13, 3, v13
  v_lshl_add_u32 v13, v11, 8, v13
  v_xor_b32 v14, 0, v12
  v_add_u32 v136, v14, v13
  v_xor_b32 v14, 32, v12
  v_add_u32 v137, v14, v13
  v_xor_b32 v14, 64, v12
  v_add_u32 v138, v14, v13
  v_xor_b32 v14, 96, v12
  v_add_u32 v139, v14, v13
  v_xor_b32 v14, 128, v12
  v_add_u32 v140, v14, v13
  v_xor_b32 v14, 160, v12
  v_add_u32 v141, v14, v13
  v_xor_b32 v14, 192, v12
  v_add_u32 v142, v14, v13
  v_xor_b32 v14, 224, v12
  v_add_u32 v143, v14, v13
  s_lshr_b32 s55, s31, 1
  s_lshl_b32 s55, s55, 10
  v_mov_b32 v10, s55
  v_mov_b32 v24, 0
  v_mov_b32 v25, 0
  v_mov_b32 v26, 0
  v_mov_b32 v27, 0
  v_mov_b32 v28, 0
  v_mov_b32 v29, 0
  v_mov_b32 v30, 0
  v_mov_b32 v31, 0
  v_mov_b32 v32, 0
  v_mov_b32 v33, 0
  v_mov_b32 v34, 0
  v_mov_b32 v35, 0
  v_mov_b32 v36, 0
  v_mov_b32 v37, 0
  v_mov_b32 v38, 0
  v_mov_b32 v39, 0
  v_mov_b32 v40, 0
  v_mov_b32 v41, 0
  v_mov_b32 v42, 0
  v_mov_b32 v43, 0
  v_mov_b32 v44, 0
  v_mov_b32 v45, 0
  v_mov_b32 v46, 0
  v_mov_b32 v47, 0
  v_mov_b32 v48, 0
  v_mov_b32 v49, 0
  v_mov_b32 v50, 0
  v_mov_b32 v51, 0
  v_mov_b32 v52, 0
  v_mov_b32 v53, 0
  v_mov_b32 v54, 0
  v_mov_b32 v55, 0
  v_mov_b32 v56, 0
  v_mov_b32 v57, 0
  v_mov_b32 v58, 0
  v_mov_b32 v59, 0
  v_mov_b32 v60, 0
  v_mov_b32 v61, 0
  v_mov_b32 v62, 0
  v_mov_b32 v63, 0
  v_mov_b32 v64, 0
  v_mov_b32 v65, 0
  v_mov_b32 v66, 0
  v_mov_b32 v67, 0
  v_mov_b32 v68, 0
  v_mov_b32 v69, 0
  v_mov_b32 v70, 0
  v_mov_b32 v71, 0
  v_mov_b32 v72, 0
  v_mov_b32 v73, 0
  v_mov_b32 v74, 0
  v_mov_b32 v75, 0
  v_mov_b32 v76, 0
  v_mov_b32 v77, 0
  v_mov_b32 v78, 0
  v_mov_b32 v79, 0
  v_mov_b32 v80, 0
  v_mov_b32 v81, 0
  v_mov_b32 v82, 0
  v_mov_b32 v83, 0
  v_mov_b32 v84, 0
  v_mov_b32 v85, 0
  v_mov_b32 v86, 0
  v_mov_b32 v87, 0
  v_readlane_b32 s16, v20, s40
  v_readlane_b32 s17, v21, s40
  s_add_u32 s40, s40, 1
  s_add_u32 m0, s41, 32768
  s_nop 2
  buffer_load_dwordx4 v2, s[12:15], s16 offen offset:0 lds
  buffer_load_dwordx4 v3, s[12:15], s16 offen offset:1024 lds
  buffer_load_dwordx4 v4, s[12:15], s16 offen offset:2048 lds
  buffer_load_dwordx4 v5, s[12:15], s16 offen offset:3072 lds
  buffer_load_dwordx4 a[32:35], v6, s[8:11], s17 offen offset:0 sc1
  buffer_load_dwordx4 a[36:39], v6, s[8:11], s17 offen offset:1024 sc1
  buffer_load_dwordx4 a[40:43], v7, s[8:11], s17 offen offset:0 sc1
  buffer_load_dwordx4 a[44:47], v7, s[8:11], s17 offen offset:1024 sc1
  s_waitcnt vmcnt(20)
  s_barrier
  ds_read_b64_tr_b16 a[64:65], v136 offset:0
  ds_read_b64_tr_b16 a[66:67], v136 offset:4096
  ds_read_b64_tr_b16 a[68:69], v137 offset:0
  ds_read_b64_tr_b16 a[70:71], v137 offset:4096
  ds_read_b64_tr_b16 a[72:73], v138 offset:0
  ds_read_b64_tr_b16 a[74:75], v138 offset:4096
  ds_read_b64_tr_b16 a[76:77], v139 offset:0
  ds_read_b64_tr_b16 a[78:79], v139 offset:4096
  ds_read_b64_tr_b16 a[80:81], v140 offset:0
  ds_read_b64_tr_b16 a[82:83], v140 offset:4096
  ds_read_b64_tr_b16 a[84:85], v141 offset:0
  ds_read_b64_tr_b16 a[86:87], v141 offset:4096
  s_waitcnt vmcnt(12)
  s_barrier
  s_waitcnt lgkmcnt(8)
  v_mfma_f32_16x16x32_bf16 v[24:27], a[64:67], a[0:3], v[24:27]
  ds_read_b64_tr_b16 a[88:89], v142 offset:0
  ds_read_b64_tr_b16 a[90:91], v142 offset:4096
  v_mfma_f32_16x16x32_bf16 v[56:59], a[64:67], a[8:11], v[56:59]
  v_readlane_b32 s16, v20, s40
  v_readlane_b32 s17, v21, s40
  v_mfma_f32_16x16x32_bf16 v[28:31], a[68:71], a[0:3], v[28:31]
  ds_read_b64_tr_b16 a[92:93], v143 offset:0
  ds_read_b64_tr_b16 a[94:95], v143 offset:4096
  v_mfma_f32_16x16x32_bf16 v[60:63], a[68:71], a[8:11], v[60:63]
  s_add_u32 s40, s40, 1
  s_add_u32 m0, s41, 49152
  s_waitcnt lgkmcnt(8)
  v_mfma_f32_16x16x32_bf16 v[32:35], a[72:75], a[0:3], v[32:35]
  ds_read_b64_tr_b16 a[64:65], v136 offset:8192
  v_mfma_f32_16x16x32_bf16 v[64:67], a[72:75], a[8:11], v[64:67]
  ds_read_b64_tr_b16 a[66:67], v136 offset:12288
  v_mfma_f32_16x16x32_bf16 v[36:39], a[76:79], a[0:3], v[36:39]
  ds_read_b64_tr_b16 a[68:69], v137 offset:8192
  v_mfma_f32_16x16x32_bf16 v[68:71], a[76:79], a[8:11], v[68:71]
  ds_read_b64_tr_b16 a[70:71], v137 offset:12288
  buffer_load_dwordx4 v2, s[12:15], s16 offen offset:0 lds
  s_waitcnt lgkmcnt(8)
  v_mfma_f32_16x16x32_bf16 v[40:43], a[80:83], a[0:3], v[40:43]
  ds_read_b64_tr_b16 a[72:73], v138 offset:8192
  v_mfma_f32_16x16x32_bf16 v[72:75], a[80:83], a[8:11], v[72:75]
  ds_read_b64_tr_b16 a[74:75], v138 offset:12288
  buffer_load_dwordx4 v3, s[12:15], s16 offen offset:1024 lds
  v_mfma_f32_16x16x32_bf16 v[44:47], a[84:87], a[0:3], v[44:47]
  ds_read_b64_tr_b16 a[76:77], v139 offset:8192
  v_mfma_f32_16x16x32_bf16 v[76:79], a[84:87], a[8:11], v[76:79]
  ds_read_b64_tr_b16 a[78:79], v139 offset:12288
  buffer_load_dwordx4 v4, s[12:15], s16 offen offset:2048 lds
  s_waitcnt lgkmcnt(8)
  v_mfma_f32_16x16x32_bf16 v[48:51], a[88:91], a[0:3], v[48:51]
  ds_read_b64_tr_b16 a[80:81], v140 offset:8192
  v_mfma_f32_16x16x32_bf16 v[80:83], a[88:91], a[8:11], v[80:83]
  ds_read_b64_tr_b16 a[82:83], v140 offset:12288
  buffer_load_dwordx4 v5, s[12:15], s16 offen offset:3072 lds
  v_mfma_f32_16x16x32_bf16 v[52:55], a[92:95], a[0:3], v[52:55]
  ds_read_b64_tr_b16 a[84:85], v141 offset:8192
  v_mfma_f32_16x16x32_bf16 v[84:87], a[92:95], a[8:11], v[84:87]
  ds_read_b64_tr_b16 a[86:87], v141 offset:12288
  buffer_load_dwordx4 a[48:51], v6, s[8:11], s17 offen offset:0 sc1
  s_waitcnt lgkmcnt(8)
  v_mfma_f32_16x16x32_bf16 v[24:27], a[64:67], a[4:7], v[24:27]
  ds_read_b64_tr_b16 a[88:89], v142 offset:8192
  v_mfma_f32_16x16x32_bf16 v[56:59], a[64:67], a[12:15], v[56:59]
  ds_read_b64_tr_b16 a[90:91], v142 offset:12288
  buffer_load_dwordx4 a[52:55], v6, s[8:11], s17 offen offset:1024 sc1
  v_mfma_f32_16x16x32_bf16 v[28:31], a[68:71], a[4:7], v[28:31]
  ds_read_b64_tr_b16 a[92:93], v143 offset:8192
  v_mfma_f32_16x16x32_bf16 v[60:63], a[68:71], a[12:15], v[60:63]
  ds_read_b64_tr_b16 a[94:95], v143 offset:12288
  buffer_load_dwordx4 a[56:59], v7, s[8:11], s17 offen offset:0 sc1
  s_waitcnt lgkmcnt(8)
  v_mfma_f32_16x16x32_bf16 v[32:35], a[72:75], a[4:7], v[32:35]
  ds_read_b64_tr_b16 a[64:65], v136 offset:16384
  v_mfma_f32_16x16x32_bf16 v[64:67], a[72:75], a[12:15], v[64:67]
  ds_read_b64_tr_b16 a[66:67], v136 offset:20480
  buffer_load_dwordx4 a[60:63], v7, s[8:11], s17 offen offset:1024 sc1
  v_mfma_f32_16x16x32_bf16 v[36:39], a[76:79], a[4:7], v[36:39]
  ds_read_b64_tr_b16 a[68:69], v137 offset:16384
  v_mfma_f32_16x16x32_bf16 v[68:71], a[76:79], a[12:15], v[68:71]
  ds_read_b64_tr_b16 a[70:71], v137 offset:20480
  s_waitcnt lgkmcnt(8)
  v_mfma_f32_16x16x32_bf16 v[40:43], a[80:83], a[4:7], v[40:43]
  ds_read_b64_tr_b16 a[72:73], v138 offset:16384
  v_mfma_f32_16x16x32_bf16 v[72:75], a[80:83], a[12:15], v[72:75]
  ds_read_b64_tr_b16 a[74:75], v138 offset:20480
  v_mfma_f32_16x16x32_bf16 v[44:47], a[84:87], a[4:7], v[44:47]
  ds_read_b64_tr_b16 a[76:77], v139 offset:16384
  v_mfma_f32_16x16x32_bf16 v[76:79], a[84:87], a[12:15], v[76:79]
  ds_read_b64_tr_b16 a[78:79], v139 offset:20480
  s_waitcnt lgkmcnt(8)
  v_mfma_f32_16x16x32_bf16 v[48:51], a[88:91], a[4:7], v[48:51]
  ds_read_b64_tr_b16 a[80:81], v140 offset:16384
  v_mfma_f32_16x16x32_bf16 v[80:83], a[88:91], a[12:15], v[80:83]
  ds_read_b64_tr_b16 a[82:83], v140 offset:20480
  v_mfma_f32_16x16x32_bf16 v[52:55], a[92:95], a[4:7], v[52:55]
  ds_read_b64_tr_b16 a[84:85], v141 offset:16384
  v_mfma_f32_16x16x32_bf16 v[84:87], a[92:95], a[12:15], v[84:87]
  ds_read_b64_tr_b16 a[86:87], v141 offset:20480
  s_mov_b32 s22, 0
L_k3_loop:
  s_waitcnt vmcnt(12)
  s_barrier
  s_cmp_eq_u32 s22, 6
  s_cbranch_scc0 L_k3_nochk
  s_mov_b32 s12, s26
  s_mov_b32 s13, s27
  s_mov_b32 s14, s28
  s_mov_b32 s75, 400000
L_k3_chk:
  v_readfirstlane_b32 s30, v8
  s_nop 0
  s_cmp_ge_u32 s30, 32
  s_cbranch_scc1 L_k3_nochk
  s_sub_u32 s75, s75, 1
  s_cmp_eq_u32 s75, 0
  s_cbranch_scc1 L_k3_nochk
  s_sleep 4
  buffer_load_dword v8, v10, s[36:39], 0 offen sc1
  s_waitcnt vmcnt(0)
  s_branch L_k3_chk
L_k3_nochk:
  s_waitcnt lgkmcnt(8)
  v_mfma_f32_16x16x32_bf16 v[24:27], a[64:67], a[16:19], v[24:27]
  ds_read_b64_tr_b16 a[88:89], v142 offset:16384
  ds_read_b64_tr_b16 a[90:91], v142 offset:20480
  v_mfma_f32_16x16x32_bf16 v[56:59], a[64:67], a[24:27], v[56:59]
  v_readlane_b32 s16, v20, s40
  v_readlane_b32 s17, v21, s40
  v_mfma_f32_16x16x32_bf16 v[28:31], a[68:71], a[16:19], v[28:31]
  ds_read_b64_tr_b16 a[92:93], v143 offset:16384
  ds_read_b64_tr_b16 a[94:95], v143 offset:20480
  v_mfma_f32_16x16x32_bf16 v[60:63], a[68:71], a[24:27], v[60:63]
  s_add_u32 s40, s40, 1
  s_add_u32 m0, s41, 0
  s_waitcnt lgkmcnt(8)
  v_mfma_f32_16x16x32_bf16 v[32:35], a[72:75], a[16:19], v[32:35]
  ds_read_b64_tr_b16 a[64:65], v136 offset:24576
  v_mfma_f32_16x16x32_bf16 v[64:67], a[72:75], a[24:27], v[64:67]
  ds_read_b64_tr_b16 a[66:67], v136 offset:28672
  v_mfma_f32_16x16x32_bf16 v[36:39], a[76:79], a[16:19], v[36:39]
  ds_read_b64_tr_b16 a[68:69], v137 offset:24576
  v_mfma_f32_16x16x32_bf16 v[68:71], a[76:79], a[24:27], v[68:71]
  ds_read_b64_tr_b16 a[70:71], v137 offset:28672
  buffer_load_dwordx4 v2, s[12:15], s16 offen offset:0 lds
  s_waitcnt lgkmcnt(8)
  v_mfma_f32_16x16x32_bf16 v[40:43], a[80:83], a[16:19], v[40:43]
  ds_read_b64_tr_b16 a[72:73], v138 offset:24576
  v_mfma_f32_16x16x32_bf16 v[72:75], a[80:83], a[24:27], v[72:75]
  ds_read_b64_tr_b16 a[74:75], v138 offset:28672
  buffer_load_dwordx4 v3, s[12:15], s16 offen offset:1024 lds
  v_mfma_f32_16x16x32_bf16 v[44:47], a[84:87], a[16:19], v[44:47]
  ds_read_b64_tr_b16 a[76:77], v139 offset:24576
  v_mfma_f32_16x16x32_bf16 v[76:79], a[84:87], a[24:27], v[76:79]
  ds_read_b64_tr_b16 a[78:79], v139 offset:28672
  buffer_load_dwordx4 v4, s[12:15], s16 offen offset:2048 lds
  s_waitcnt lgkmcnt(8)
  v_mfma_f32_16x16x32_bf16 v[48:51], a[88:91], a[16:19], v[48:51]
  ds_read_b64_tr_b16 a[80:81], v140 offset:24576
  v_mfma_f32_16x16x32_bf16 v[80:83], a[88:91], a[24:27], v[80:83]
  ds_read_b64_tr_b16 a[82:83], v140 offset:28672
  buffer_load_dwordx4 v5, s[12:15], s16 offen offset:3072 lds
  v_mfma_f32_16x16x32_bf16 v[52:55], a[92:95], a[16:19], v[52:55]
  ds_read_b64_tr_b16 a[84:85], v141 offset:24576
  v_mfma_f32_16x16x32_bf16 v[84:87], a[92:95], a[24:27], v[84:87]
  ds_read_b64_tr_b16 a[86:87], v141 offset:28672
  buffer_load_dwordx4 a[0:3], v6, s[8:11], s17 offen offset:0 sc1
  s_waitcnt lgkmcnt(8)
  v_mfma_f32_16x16x32_bf16 v[24:27], a[64:67], a[20:23], v[24:27]
  ds_read_b64_tr_b16 a[88:89], v142 offset:24576
  v_mfma_f32_16x16x32_bf16 v[56:59], a[64:67], a[28:31], v[56:59]
  ds_read_b64_tr_b16 a[90:91], v142 offset:28672
  buffer_load_dwordx4 a[4:7], v6, s[8:11], s17 offen offset:1024 sc1
  v_mfma_f32_16x16x32_bf16 v[28:31], a[68:71], a[20:23], v[28:31]
  ds_read_b64_tr_b16 a[92:93], v143 offset:24576
  v_mfma_f32_16x16x32_bf16 v[60:63], a[68:71], a[28:31], v[60:63]
  ds_read_b64_tr_b16 a[94:95], v143 offset:28672
  buffer_load_dwordx4 a[8:11], v7, s[8:11], s17 offen offset:0 sc1
  s_waitcnt lgkmcnt(8)
  v_mfma_f32_16x16x32_bf16 v[32:35], a[72:75], a[20:23], v[32:35]
  ds_read_b64_tr_b16 a[64:65], v136 offset:32768
  v_mfma_f32_16x16x32_bf16 v[64:67], a[72:75], a[28:31], v[64:67]
  ds_read_b64_tr_b16 a[66:67], v136 offset:36864
  buffer_load_dwordx4 a[12:15], v7, s[8:11], s17 offen offset:1024 sc1
  v_mfma_f32_16x16x32_bf16 v[36:39], a[76:79], a[20:23], v[36:39]
  ds_read_b64_tr_b16 a[68:69], v137 offset:32768
  v_mfma_f32_16x16x32_bf16 v[68:71], a[76:79], a[28:31], v[68:71]
  ds_read_b64_tr_b16 a[70:71], v137 offset:36864
  s_waitcnt lgkmcnt(8)
  v_mfma_f32_16x16x32_bf16 v[40:43], a[80:83], a[20:23], v[40:43]
  ds_read_b64_tr_b16 a[72:73], v138 offset:32768
  v_mfma_f32_16x16x32_bf16 v[72:75], a[80:83], a[28:31], v[72:75]
  ds_read_b64_tr_b16 a[74:75], v138 offset:36864
  v_mfma_f32_16x16x32_bf16 v[44:47], a[84:87], a[20:23], v[44:47]
  ds_read_b64_tr_b16 a[76:77], v139 offset:32768
  v_mfma_f32_16x16x32_bf16 v[76:79], a[84:87], a[28:31], v[76:79]
  ds_read_b64_tr_b16 a[78:79], v139 offset:36864
  s_waitcnt lgkmcnt(8)
  v_mfma_f32_16x16x32_bf16 v[48:51], a[88:91], a[20:23], v[48:51]
  ds_read_b64_tr_b16 a[80:81], v140 offset:32768
  v_mfma_f32_16x16x32_bf16 v[80:83], a[88:91], a[28:31], v[80:83]
  ds_read_b64_tr_b16 a[82:83], v140 offset:36864
  v_mfma_f32_16x16x32_bf16 v[52:55], a[92:95], a[20:23], v[52:55]
  ds_read_b64_tr_b16 a[84:85], v141 offset:32768
  v_mfma_f32_16x16x32_bf16 v[84:87], a[92:95], a[28:31], v[84:87]
  ds_read_b64_tr_b16 a[86:87], v141 offset:36864
  s_waitcnt vmcnt(12)
  s_barrier
  s_cmp_eq_u32 s22, 5
  s_cbranch_scc0 L_k3_nopoll
  buffer_load_dword v8, v10, s[36:39], 0 offen sc1
L_k3_nopoll:
  s_waitcnt lgkmcnt(8)
  v_mfma_f32_16x16x32_bf16 v[24:27], a[64:67], a[32:35], v[24:27]
  ds_read_b64_tr_b16 a[88:89], v142 offset:32768
  ds_read_b64_tr_b16 a[90:91], v142 offset:36864
  v_mfma_f32_16x16x32_bf16 v[56:59], a[64:67], a[40:43], v[56:59]
  v_readlane_b32 s16, v20, s40
  v_readlane_b32 s17, v21, s40
  v_mfma_f32_16x16x32_bf16 v[28:31], a[68:71], a[32:35], v[28:31]
  ds_read_b64_tr_b16 a[92:93], v143 offset:32768
  ds_read_b64_tr_b16 a[94:95], v143 offset:36864
  v_mfma_f32_16x16x32_bf16 v[60:63], a[68:71], a[40:43], v[60:63]
  s_add_u32 s40, s40, 1
  s_add_u32 m0, s41, 16384
  s_waitcnt lgkmcnt(8)
  v_mfma_f32_16x16x32_bf16 v[32:35], a[72:75], a[32:35], v[32:35]
  ds_read_b64_tr_b16 a[64:65], v136 offset:40960
  v_mfma_f32_16x16x32_bf16 v[64:67], a[72:75], a[40:43], v[64:67]
  ds_read_b64_tr_b16 a[66:67], v136 offset:45056
  v_mfma_f32_16x16x32_bf16 v[36:39], a[76:79], a[32:35], v[36:39]
  ds_read_b64_tr_b16 a[68:69], v137 offset:40960
  v_mfma_f32_16x16x32_bf16 v[68:71], a[76:79], a[40:43], v[68:71]
  ds_read_b64_tr_b16 a[70:71], v137 offset:45056
  buffer_load_dwordx4 v2, s[12:15], s16 offen offset:0 lds
  s_waitcnt lgkmcnt(8)
  v_mfma_f32_16x16x32_bf16 v[40:43], a[80:83], a[32:35], v[40:43]
  ds_read_b64_tr_b16 a[72:73], v138 offset:40960
  v_mfma_f32_16x16x32_bf16 v[72:75], a[80:83], a[40:43], v[72:75]
  ds_read_b64_tr_b16 a[74:75], v138 offset:45056
  buffer_load_dwordx4 v3, s[12:15], s16 offen offset:1024 lds
  v_mfma_f32_16x16x32_bf16 v[44:47], a[84:87], a[32:35], v[44:47]
  ds_read_b64_tr_b16 a[76:77], v139 offset:40960
  v_mfma_f32_16x16x32_bf16 v[76:79], a[84:87], a[40:43], v[76:79]
  ds_read_b64_tr_b16 a[78:79], v139 offset:45056
  buffer_load_dwordx4 v4, s[12:15], s16 offen offset:2048 lds
  s_waitcnt lgkmcnt(8)
  v_mfma_f32_16x16x32_bf16 v[48:51], a[88:91], a[32:35], v[48:51]
  ds_read_b64_tr_b16 a[80:81], v140 offset:40960
  v_mfma_f32_16x16x32_bf16 v[80:83], a[88:91], a[40:43], v[80:83]
  ds_read_b64_tr_b16 a[82:83], v140 offset:45056
  buffer_load_dwordx4 v5, s[12:15], s16 offen offset:3072 lds
  v_mfma_f32_16x16x32_bf16 v[52:55], a[92:95], a[32:35], v[52:55]
  ds_read_b64_tr_b16 a[84:85], v141 offset:40960
  v_mfma_f32_16x16x32_bf16 v[84:87], a[92:95], a[40:43], v[84:87]
  ds_read_b64_tr_b16 a[86:87], v141 offset:45056
  buffer_load_dwordx4 a[16:19], v6, s[8:11], s17 offen offset:0 sc1
  s_waitcnt lgkmcnt(8)
  v_mfma_f32_16x16x32_bf16 v[24:27], a[64:67], a[36:39], v[24:27]
  ds_read_b64_tr_b16 a[88:89], v142 offset:40960
  v_mfma_f32_16x16x32_bf16 v[56:59], a[64:67], a[44:47], v[56:59]
  ds_read_b64_tr_b16 a[90:91], v142 offset:45056
  buffer_load_dwordx4 a[20:23], v6, s[8:11], s17 offen offset:1024 sc1
  v_mfma_f32_16x16x32_bf16 v[28:31], a[68:71], a[36:39], v[28:31]
  ds_read_b64_tr_b16 a[92:93], v143 offset:40960
  v_mfma_f32_16x16x32_bf16 v[60:63], a[68:71], a[44:47], v[60:63]
  ds_read_b64_tr_b16 a[94:95], v143 offset:45056
  buffer_load_dwordx4 a[24:27], v7, s[8:11], s17 offen offset:0 sc1
  s_waitcnt lgkmcnt(8)
  v_mfma_f32_16x16x32_bf16 v[32:35], a[72:75], a[36:39], v[32:35]
  ds_read_b64_tr_b16 a[64:65], v136 offset:49152
  v_mfma_f32_16x16x32_bf16 v[64:67], a[72:75], a[44:47], v[64:67]
  ds_read_b64_tr_b16 a[66:67], v136 offset:53248
  buffer_load_dwordx4 a[28:31], v7, s[8:11], s17 offen offset:1024 sc1
  v_mfma_f32_16x16x32_bf16 v[36:39], a[76:79], a[36:39], v[36:39]
  ds_read_b64_tr_b16 a[68:69], v137 offset:49152
  v_mfma_f32_16x16x32_bf16 v[68:71], a[76:79], a[44:47], v[68:71]
  ds_read_b64_tr_b16 a[70:71], v137 offset:53248
  s_waitcnt lgkmcnt(8)
  v_mfma_f32_16x16x32_bf16 v[40:43], a[80:83], a[36:39], v[40:43]
  ds_read_b64_tr_b16 a[72:73], v138 offset:49152
  v_mfma_f32_16x16x32_bf16 v[72:75], a[80:83], a[44:47], v[72:75]
  ds_read_b64_tr_b16 a[74:75], v138 offset:53248
  v_mfma_f32_16x16x32_bf16 v[44:47], a[84:87], a[36:39], v[44:47]
  ds_read_b64_tr_b16 a[76:77], v139 offset:49152
  v_mfma_f32_16x16x32_bf16 v[76:79], a[84:87], a[44:47], v[76:79]
  ds_read_b64_tr_b16 a[78:79], v139 offset:53248
  s_waitcnt lgkmcnt(8)
  v_mfma_f32_16x16x32_bf16 v[48:51], a[88:91], a[36:39], v[48:51]
  ds_read_b64_tr_b16 a[80:81], v140 offset:49152
  v_mfma_f32_16x16x32_bf16 v[80:83], a[88:91], a[44:47], v[80:83]
  ds_read_b64_tr_b16 a[82:83], v140 offset:53248
  v_mfma_f32_16x16x32_bf16 v[52:55], a[92:95], a[36:39], v[52:55]
  ds_read_b64_tr_b16 a[84:85], v141 offset:49152
  v_mfma_f32_16x16x32_bf16 v[84:87], a[92:95], a[44:47], v[84:87]
  ds_read_b64_tr_b16 a[86:87], v141 offset:53248
  s_waitcnt vmcnt(12)
  s_barrier
  s_waitcnt lgkmcnt(8)
  v_mfma_f32_16x16x32_bf16 v[24:27], a[64:67], a[48:51], v[24:27]
  ds_read_b64_tr_b16 a[88:89], v142 offset:49152
  ds_read_b64_tr_b16 a[90:91], v142 offset:53248
  v_mfma_f32_16x16x32_bf16 v[56:59], a[64:67], a[56:59], v[56:59]
  v_readlane_b32 s16, v20, s40
  v_readlane_b32 s17, v21, s40
  v_mfma_f32_16x16x32_bf16 v[28:31], a[68:71], a[48:51], v[28:31]
  ds_read_b64_tr_b16 a[92:93], v143 offset:49152
  ds_read_b64_tr_b16 a[94:95], v143 offset:53248
  v_mfma_f32_16x16x32_bf16 v[60:63], a[68:71], a[56:59], v[60:63]
  s_add_u32 s40, s40, 1
  s_add_u32 m0, s41, 32768
  s_waitcnt lgkmcnt(8)
  v_mfma_f32_16x16x32_bf16 v[32:35], a[72:75], a[48:51], v[32:35]
  ds_read_b64_tr_b16 a[64:65], v136 offset:57344
  v_mfma_f32_16x16x32_bf16 v[64:67], a[72:75], a[56:59], v[64:67]
  ds_read_b64_tr_b16 a[66:67], v136 offset:61440
  v_mfma_f32_16x16x32_bf16 v[36:39], a[76:79], a[48:51], v[36:39]
  ds_read_b64_tr_b16 a[68:69], v137 offset:57344
  v_mfma_f32_16x16x32_bf16 v[68:71], a[76:79], a[56:59], v[68:71]
  ds_read_b64_tr_b16 a[70:71], v137 offset:61440
  buffer_load_dwordx4 v2, s[12:15], s16 offen offset:0 lds
  s_waitcnt lgkmcnt(8)
  v_mfma_f32_16x16x32_bf16 v[40:43], a[80:83], a[48:51], v[40:43]
  ds_read_b64_tr_b16 a[72:73], v138 offset:57344
  v_mfma_f32_16x16x32_bf16 v[72:75], a[80:83], a[56:59], v[72:75]
  ds_read_b64_tr_b16 a[74:75], v138 offset:61440
  buffer_load_dwordx4 v3, s[12:15], s16 offen offset:1024 lds
  v_mfma_f32_16x16x32_bf16 v[44:47], a[84:87], a[48:51], v[44:47]
  ds_read_b64_tr_b16 a[76:77], v139 offset:57344
  v_mfma_f32_16x16x32_bf16 v[76:79], a[84:87], a[56:59], v[76:79]
  ds_read_b64_tr_b16 a[78:79], v139 offset:61440
  buffer_load_dwordx4 v4, s[12:15], s16 offen offset:2048 lds
  s_waitcnt lgkmcnt(8)
  v_mfma_f32_16x16x32_bf16 v[48:51], a[88:91], a[48:51], v[48:51]
  ds_read_b64_tr_b16 a[80:81], v140 offset:57344
  v_mfma_f32_16x16x32_bf16 v[80:83], a[88:91], a[56:59], v[80:83]
  ds_read_b64_tr_b16 a[82:83], v140 offset:61440
  buffer_load_dwordx4 v5, s[12:15], s16 offen offset:3072 lds
  v_mfma_f32_16x16x32_bf16 v[52:55], a[92:95], a[48:51], v[52:55]
  ds_read_b64_tr_b16 a[84:85], v141 offset:57344
  v_mfma_f32_16x16x32_bf16 v[84:87], a[92:95], a[56:59], v[84:87]
  ds_read_b64_tr_b16 a[86:87], v141 offset:61440
  buffer_load_dwordx4 a[32:35], v6, s[8:11], s17 offen offset:0 sc1
  s_waitcnt lgkmcnt(8)
  v_mfma_f32_16x16x32_bf16 v[24:27], a[64:67], a[52:55], v[24:27]
  ds_read_b64_tr_b16 a[88:89], v142 offset:57344
  v_mfma_f32_16x16x32_bf16 v[56:59], a[64:67], a[60:63], v[56:59]
  ds_read_b64_tr_b16 a[90:91], v142 offset:61440
  buffer_load_dwordx4 a[36:39], v6, s[8:11], s17 offen offset:1024 sc1
  v_mfma_f32_16x16x32_bf16 v[28:31], a[68:71], a[52:55], v[28:31]
  ds_read_b64_tr_b16 a[92:93], v143 offset:57344
  v_mfma_f32_16x16x32_bf16 v[60:63], a[68:71], a[60:63], v[60:63]
  ds_read_b64_tr_b16 a[94:95], v143 offset:61440
  buffer_load_dwordx4 a[40:43], v7, s[8:11], s17 offen offset:0 sc1
  s_waitcnt lgkmcnt(8)
  v_mfma_f32_16x16x32_bf16 v[32:35], a[72:75], a[52:55], v[32:35]
  ds_read_b64_tr_b16 a[64:65], v136 offset:0
  v_mfma_f32_16x16x32_bf16 v[64:67], a[72:75], a[60:63], v[64:67]
  ds_read_b64_tr_b16 a[66:67], v136 offset:4096
  buffer_load_dwordx4 a[44:47], v7, s[8:11], s17 offen offset:1024 sc1
  v_mfma_f32_16x16x32_bf16 v[36:39], a[76:79], a[52:55], v[36:39]
  ds_read_b64_tr_b16 a[68:69], v137 offset:0
  v_mfma_f32_16x16x32_bf16 v[68:71], a[76:79], a[60:63], v[68:71]
  ds_read_b64_tr_b16 a[70:71], v137 offset:4096
  s_waitcnt lgkmcnt(8)
  v_mfma_f32_16x16x32_bf16 v[40:43], a[80:83], a[52:55], v[40:43]
  ds_read_b64_tr_b16 a[72:73], v138 offset:0
  v_mfma_f32_16x16x32_bf16 v[72:75], a[80:83], a[60:63], v[72:75]
  ds_read_b64_tr_b16 a[74:75], v138 offset:4096
  v_mfma_f32_16x16x32_bf16 v[44:47], a[84:87], a[52:55], v[44:47]
  ds_read_b64_tr_b16 a[76:77], v139 offset:0
  v_mfma_f32_16x16x32_bf16 v[76:79], a[84:87], a[60:63], v[76:79]
  ds_read_b64_tr_b16 a[78:79], v139 offset:4096
  s_waitcnt lgkmcnt(8)
  v_mfma_f32_16x16x32_bf16 v[48:51], a[88:91], a[52:55], v[48:51]
  ds_read_b64_tr_b16 a[80:81], v140 offset:0
  v_mfma_f32_16x16x32_bf16 v[80:83], a[88:91], a[60:63], v[80:83]
  ds_read_b64_tr_b16 a[82:83], v140 offset:4096
  v_mfma_f32_16x16x32_bf16 v[52:55], a[92:95], a[52:55], v[52:55]
  ds_read_b64_tr_b16 a[84:85], v141 offset:0
  v_mfma_f32_16x16x32_bf16 v[84:87], a[92:95], a[60:63], v[84:87]
  ds_read_b64_tr_b16 a[86:87], v141 offset:4096
  s_waitcnt vmcnt(12)
  s_barrier
  s_waitcnt lgkmcnt(8)
  v_mfma_f32_16x16x32_bf16 v[24:27], a[64:67], a[0:3], v[24:27]
  ds_read_b64_tr_b16 a[88:89], v142 offset:0
  ds_read_b64_tr_b16 a[90:91], v142 offset:4096
  v_mfma_f32_16x16x32_bf16 v[56:59], a[64:67], a[8:11], v[56:59]
  v_readlane_b32 s16, v20, s40
  v_readlane_b32 s17, v21, s40
  v_mfma_f32_16x16x32_bf16 v[28:31], a[68:71], a[0:3], v[28:31]
  ds_read_b64_tr_b16 a[92:93], v143 offset:0
  ds_read_b64_tr_b16 a[94:95], v143 offset:4096
  v_mfma_f32_16x16x32_bf16 v[60:63], a[68:71], a[8:11], v[60:63]
  s_add_u32 s40, s40, 1
  s_add_u32 m0, s41, 49152
  s_waitcnt lgkmcnt(8)
  v_mfma_f32_16x16x32_bf16 v[32:35], a[72:75], a[0:3], v[32:35]
  ds_read_b64_tr_b16 a[64:65], v136 offset:8192
  v_mfma_f32_16x16x32_bf16 v[64:67], a[72:75], a[8:11], v[64:67]
  ds_read_b64_tr_b16 a[66:67], v136 offset:12288
  v_mfma_f32_16x16x32_bf16 v[36:39], a[76:79], a[0:3], v[36:39]
  ds_read_b64_tr_b16 a[68:69], v137 offset:8192
  v_mfma_f32_16x16x32_bf16 v[68:71], a[76:79], a[8:11], v[68:71]
  ds_read_b64_tr_b16 a[70:71], v137 offset:12288
  buffer_load_dwordx4 v2, s[12:15], s16 offen offset:0 lds
  s_waitcnt lgkmcnt(8)
  v_mfma_f32_16x16x32_bf16 v[40:43], a[80:83], a[0:3], v[40:43]
  ds_read_b64_tr_b16 a[72:73], v138 offset:8192
  v_mfma_f32_16x16x32_bf16 v[72:75], a[80:83], a[8:11], v[72:75]
  ds_read_b64_tr_b16 a[74:75], v138 offset:12288
  buffer_load_dwordx4 v3, s[12:15], s16 offen offset:1024 lds
  v_mfma_f32_16x16x32_bf16 v[44:47], a[84:87], a[0:3], v[44:47]
  ds_read_b64_tr_b16 a[76:77], v139 offset:8192
  v_mfma_f32_16x16x32_bf16 v[76:79], a[84:87], a[8:11], v[76:79]
  ds_read_b64_tr_b16 a[78:79], v139 offset:12288
  buffer_load_dwordx4 v4, s[12:15], s16 offen offset:2048 lds
  s_waitcnt lgkmcnt(8)
  v_mfma_f32_16x16x32_bf16 v[48:51], a[88:91], a[0:3], v[48:51]
  ds_read_b64_tr_b16 a[80:81], v140 offset:8192
  v_mfma_f32_16x16x32_bf16 v[80:83], a[88:91], a[8:11], v[80:83]
  ds_read_b64_tr_b16 a[82:83], v140 offset:12288
  buffer_load_dwordx4 v5, s[12:15], s16 offen offset:3072 lds
  v_mfma_f32_16x16x32_bf16 v[52:55], a[92:95], a[0:3], v[52:55]
  ds_read_b64_tr_b16 a[84:85], v141 offset:8192
  v_mfma_f32_16x16x32_bf16 v[84:87], a[92:95], a[8:11], v[84:87]
  ds_read_b64_tr_b16 a[86:87], v141 offset:12288
  buffer_load_dwordx4 a[48:51], v6, s[8:11], s17 offen offset:0 sc1
  s_waitcnt lgkmcnt(8)
  v_mfma_f32_16x16x32_bf16 v[24:27], a[64:67], a[4:7], v[24:27]
  ds_read_b64_tr_b16 a[88:89], v142 offset:8192
  v_mfma_f32_16x16x32_bf16 v[56:59], a[64:67], a[12:15], v[56:59]
  ds_read_b64_tr_b16 a[90:91], v142 offset:12288
  buffer_load_dwordx4 a[52:55], v6, s[8:11], s17 offen offset:1024 sc1
  v_mfma_f32_16x16x32_bf16 v[28:31], a[68:71], a[4:7], v[28:31]
  ds_read_b64_tr_b16 a[92:93], v143 offset:8192
  v_mfma_f32_16x16x32_bf16 v[60:63], a[68:71], a[12:15], v[60:63]
  ds_read_b64_tr_b16 a[94:95], v143 offset:12288
  buffer_load_dwordx4 a[56:59], v7, s[8:11], s17 offen offset:0 sc1
  s_waitcnt lgkmcnt(8)
  v_mfma_f32_16x16x32_bf16 v[32:35], a[72:75], a[4:7], v[32:35]
  ds_read_b64_tr_b16 a[64:65], v136 offset:16384
  v_mfma_f32_16x16x32_bf16 v[64:67], a[72:75], a[12:15], v[64:67]
  ds_read_b64_tr_b16 a[66:67], v136 offset:20480
  buffer_load_dwordx4 a[60:63], v7, s[8:11], s17 offen offset:1024 sc1
  v_mfma_f32_16x16x32_bf16 v[36:39], a[76:79], a[4:7], v[36:39]
  ds_read_b64_tr_b16 a[68:69], v137 offset:16384
  v_mfma_f32_16x16x32_bf16 v[68:71], a[76:79], a[12:15], v[68:71]
  ds_read_b64_tr_b16 a[70:71], v137 offset:20480
  s_waitcnt lgkmcnt(8)
  v_mfma_f32_16x16x32_bf16 v[40:43], a[80:83], a[4:7], v[40:43]
  ds_read_b64_tr_b16 a[72:73], v138 offset:16384
  v_mfma_f32_16x16x32_bf16 v[72:75], a[80:83], a[12:15], v[72:75]
  ds_read_b64_tr_b16 a[74:75], v138 offset:20480
  v_mfma_f32_16x16x32_bf16 v[44:47], a[84:87], a[4:7], v[44:47]
  ds_read_b64_tr_b16 a[76:77], v139 offset:16384
  v_mfma_f32_16x16x32_bf16 v[76:79], a[84:87], a[12:15], v[76:79]
  ds_read_b64_tr_b16 a[78:79], v139 offset:20480
  s_waitcnt lgkmcnt(8)
  v_mfma_f32_16x16x32_bf16 v[48:51], a[88:91], a[4:7], v[48:51]
  ds_read_b64_tr_b16 a[80:81], v140 offset:16384
  v_mfma_f32_16x16x32_bf16 v[80:83], a[88:91], a[12:15], v[80:83]
  ds_read_b64_tr_b16 a[82:83], v140 offset:20480
  v_mfma_f32_16x16x32_bf16 v[52:55], a[92:95], a[4:7], v[52:55]
  ds_read_b64_tr_b16 a[84:85], v141 offset:16384
  v_mfma_f32_16x16x32_bf16 v[84:87], a[92:95], a[12:15], v[84:87]
  ds_read_b64_tr_b16 a[86:87], v141 offset:20480
  s_add_u32 s22, s22, 1
  s_cmp_lt_u32 s22, 8
  s_cbranch_scc1 L_k3_loop
  s_waitcnt vmcnt(12)
  s_barrier
  s_waitcnt lgkmcnt(8)
  v_mfma_f32_16x16x32_bf16 v[24:27], a[64:67], a[16:19], v[24:27]
  ds_read_b64_tr_b16 a[88:89], v142 offset:16384
  v_mfma_f32_16x16x32_bf16 v[56:59], a[64:67], a[24:27], v[56:59]
  ds_read_b64_tr_b16 a[90:91], v142 offset:20480
  v_mfma_f32_16x16x32_bf16 v[28:31], a[68:71], a[16:19], v[28:31]
  ds_read_b64_tr_b16 a[92:93], v143 offset:16384
  v_mfma_f32_16x16x32_bf16 v[60:63], a[68:71], a[24:27], v[60:63]
  ds_read_b64_tr_b16 a[94:95], v143 offset:20480
  s_waitcnt lgkmcnt(8)
  v_mfma_f32_16x16x32_bf16 v[32:35], a[72:75], a[16:19], v[32:35]
  ds_read_b64_tr_b16 a[64:65], v136 offset:24576
  v_mfma_f32_16x16x32_bf16 v[64:67], a[72:75], a[24:27], v[64:67]
  ds_read_b64_tr_b16 a[66:67], v136 offset:28672
  v_mfma_f32_16x16x32_bf16 v[36:39], a[76:79], a[16:19], v[36:39]
  ds_read_b64_tr_b16 a[68:69], v137 offset:24576
  v_mfma_f32_16x16x32_bf16 v[68:71], a[76:79], a[24:27], v[68:71]
  ds_read_b64_tr_b16 a[70:71], v137 offset:28672
  s_waitcnt lgkmcnt(8)
  v_mfma_f32_16x16x32_bf16 v[40:43], a[80:83], a[16:19], v[40:43]
  ds_read_b64_tr_b16 a[72:73], v138 offset:24576
  v_mfma_f32_16x16x32_bf16 v[72:75], a[80:83], a[24:27], v[72:75]
  ds_read_b64_tr_b16 a[74:75], v138 offset:28672
  v_mfma_f32_16x16x32_bf16 v[44:47], a[84:87], a[16:19], v[44:47]
  ds_read_b64_tr_b16 a[76:77], v139 offset:24576
  v_mfma_f32_16x16x32_bf16 v[76:79], a[84:87], a[24:27], v[76:79]
  ds_read_b64_tr_b16 a[78:79], v139 offset:28672
  s_waitcnt lgkmcnt(8)
  v_mfma_f32_16x16x32_bf16 v[48:51], a[88:91], a[16:19], v[48:51]
  ds_read_b64_tr_b16 a[80:81], v140 offset:24576
  v_mfma_f32_16x16x32_bf16 v[80:83], a[88:91], a[24:27], v[80:83]
  ds_read_b64_tr_b16 a[82:83], v140 offset:28672
  v_mfma_f32_16x16x32_bf16 v[52:55], a[92:95], a[16:19], v[52:55]
  ds_read_b64_tr_b16 a[84:85], v141 offset:24576
  v_mfma_f32_16x16x32_bf16 v[84:87], a[92:95], a[24:27], v[84:87]
  ds_read_b64_tr_b16 a[86:87], v141 offset:28672
  s_waitcnt lgkmcnt(8)
  v_mfma_f32_16x16x32_bf16 v[24:27], a[64:67], a[20:23], v[24:27]
  ds_read_b64_tr_b16 a[88:89], v142 offset:24576
  v_mfma_f32_16x16x32_bf16 v[56:59], a[64:67], a[28:31], v[56:59]
  ds_read_b64_tr_b16 a[90:91], v142 offset:28672
  v_mfma_f32_16x16x32_bf16 v[28:31], a[68:71], a[20:23], v[28:31]
  ds_read_b64_tr_b16 a[92:93], v143 offset:24576
  v_mfma_f32_16x16x32_bf16 v[60:63], a[68:71], a[28:31], v[60:63]
  ds_read_b64_tr_b16 a[94:95], v143 offset:28672
  s_waitcnt lgkmcnt(8)
  v_mfma_f32_16x16x32_bf16 v[32:35], a[72:75], a[20:23], v[32:35]
  ds_read_b64_tr_b16 a[64:65], v136 offset:32768
  v_mfma_f32_16x16x32_bf16 v[64:67], a[72:75], a[28:31], v[64:67]
  ds_read_b64_tr_b16 a[66:67], v136 offset:36864
  v_mfma_f32_16x16x32_bf16 v[36:39], a[76:79], a[20:23], v[36:39]
  ds_read_b64_tr_b16 a[68:69], v137 offset:32768
  ds_read_b64_tr_b16 a[70:71], v137 offset:36864
  v_mfma_f32_16x16x32_bf16 v[68:71], a[76:79], a[28:31], v[68:71]
  buffer_load_dwordx4 v[88:91], v9, s[68:71], s92 offen
  buffer_load_dwordx4 v[92:95], v9, s[68:71], s93 offen
  s_waitcnt lgkmcnt(8)
  v_mfma_f32_16x16x32_bf16 v[40:43], a[80:83], a[20:23], v[40:43]
  ds_read_b64_tr_b16 a[72:73], v138 offset:32768
  ds_read_b64_tr_b16 a[74:75], v138 offset:36864
  v_mfma_f32_16x16x32_bf16 v[72:75], a[80:83], a[28:31], v[72:75]
  buffer_load_dwordx4 v[96:99], v9, s[68:71], s94 offen
  buffer_load_dwordx4 v[100:103], v9, s[68:71], s95 offen
  v_mfma_f32_16x16x32_bf16 v[44:47], a[84:87], a[20:23], v[44:47]
  ds_read_b64_tr_b16 a[76:77], v139 offset:32768
  v_mfma_f32_16x16x32_bf16 v[76:79], a[84:87], a[28:31], v[76:79]
  ds_read_b64_tr_b16 a[78:79], v139 offset:36864
  s_waitcnt lgkmcnt(8)
  v_mfma_f32_16x16x32_bf16 v[48:51], a[88:91], a[20:23], v[48:51]
  ds_read_b64_tr_b16 a[80:81], v140 offset:32768
  v_mfma_f32_16x16x32_bf16 v[80:83], a[88:91], a[28:31], v[80:83]
  ds_read_b64_tr_b16 a[82:83], v140 offset:36864
  v_mfma_f32_16x16x32_bf16 v[52:55], a[92:95], a[20:23], v[52:55]
  ds_read_b64_tr_b16 a[84:85], v141 offset:32768
  v_mfma_f32_16x16x32_bf16 v[84:87], a[92:95], a[28:31], v[84:87]
  ds_read_b64_tr_b16 a[86:87], v141 offset:36864
  s_waitcnt vmcnt(8)
  s_barrier
  s_waitcnt lgkmcnt(8)
  v_mfma_f32_16x16x32_bf16 v[24:27], a[64:67], a[32:35], v[24:27]
  ds_read_b64_tr_b16 a[88:89], v142 offset:32768
  v_mfma_f32_16x16x32_bf16 v[56:59], a[64:67], a[40:43], v[56:59]
  ds_read_b64_tr_b16 a[90:91], v142 offset:36864
  v_mfma_f32_16x16x32_bf16 v[28:31], a[68:71], a[32:35], v[28:31]
  ds_read_b64_tr_b16 a[92:93], v143 offset:32768
  v_mfma_f32_16x16x32_bf16 v[60:63], a[68:71], a[40:43], v[60:63]
  ds_read_b64_tr_b16 a[94:95], v143 offset:36864
  s_waitcnt lgkmcnt(8)
  v_mfma_f32_16x16x32_bf16 v[32:35], a[72:75], a[32:35], v[32:35]
  ds_read_b64_tr_b16 a[64:65], v136 offset:40960
  v_mfma_f32_16x16x32_bf16 v[64:67], a[72:75], a[40:43], v[64:67]
  ds_read_b64_tr_b16 a[66:67], v136 offset:45056
  v_mfma_f32_16x16x32_bf16 v[36:39], a[76:79], a[32:35], v[36:39]
  ds_read_b64_tr_b16 a[68:69], v137 offset:40960
  v_mfma_f32_16x16x32_bf16 v[68:71], a[76:79], a[40:43], v[68:71]
  ds_read_b64_tr_b16 a[70:71], v137 offset:45056
  s_waitcnt lgkmcnt(8)
  v_mfma_f32_16x16x32_bf16 v[40:43], a[80:83], a[32:35], v[40:43]
  ds_read_b64_tr_b16 a[72:73], v138 offset:40960
  v_mfma_f32_16x16x32_bf16 v[72:75], a[80:83], a[40:43], v[72:75]
  ds_read_b64_tr_b16 a[74:75], v138 offset:45056
  v_mfma_f32_16x16x32_bf16 v[44:47], a[84:87], a[32:35], v[44:47]
  ds_read_b64_tr_b16 a[76:77], v139 offset:40960
  v_mfma_f32_16x16x32_bf16 v[76:79], a[84:87], a[40:43], v[76:79]
  ds_read_b64_tr_b16 a[78:79], v139 offset:45056
  s_waitcnt lgkmcnt(8)
  v_mfma_f32_16x16x32_bf16 v[48:51], a[88:91], a[32:35], v[48:51]
  ds_read_b64_tr_b16 a[80:81], v140 offset:40960
  v_mfma_f32_16x16x32_bf16 v[80:83], a[88:91], a[40:43], v[80:83]
  ds_read_b64_tr_b16 a[82:83], v140 offset:45056
  v_mfma_f32_16x16x32_bf16 v[52:55], a[92:95], a[32:35], v[52:55]
  ds_read_b64_tr_b16 a[84:85], v141 offset:40960
  v_mfma_f32_16x16x32_bf16 v[84:87], a[92:95], a[40:43], v[84:87]
  ds_read_b64_tr_b16 a[86:87], v141 offset:45056
  s_waitcnt lgkmcnt(8)
  v_mfma_f32_16x16x32_bf16 v[24:27], a[64:67], a[36:39], v[24:27]
  ds_read_b64_tr_b16 a[88:89], v142 offset:40960
  v_mfma_f32_16x16x32_bf16 v[56:59], a[64:67], a[44:47], v[56:59]
  ds_read_b64_tr_b16 a[90:91], v142 offset:45056
  v_mfma_f32_16x16x32_bf16 v[28:31], a[68:71], a[36:39], v[28:31]
  ds_read_b64_tr_b16 a[92:93], v143 offset:40960
  v_mfma_f32_16x16x32_bf16 v[60:63], a[68:71], a[44:47], v[60:63]
  ds_read_b64_tr_b16 a[94:95], v143 offset:45056
  s_waitcnt lgkmcnt(8)
  v_mfma_f32_16x16x32_bf16 v[32:35], a[72:75], a[36:39], v[32:35]
  ds_read_b64_tr_b16 a[64:65], v136 offset:49152
  v_mfma_f32_16x16x32_bf16 v[64:67], a[72:75], a[44:47], v[64:67]
  ds_read_b64_tr_b16 a[66:67], v136 offset:53248
  v_mfma_f32_16x16x32_bf16 v[36:39], a[76:79], a[36:39], v[36:39]
  ds_read_b64_tr_b16 a[68:69], v137 offset:49152
  v_mfma_f32_16x16x32_bf16 v[68:71], a[76:79], a[44:47], v[68:71]
  ds_read_b64_tr_b16 a[70:71], v137 offset:53248
  s_waitcnt lgkmcnt(8)
  v_mfma_f32_16x16x32_bf16 v[40:43], a[80:83], a[36:39], v[40:43]
  ds_read_b64_tr_b16 a[72:73], v138 offset:49152
  v_mfma_f32_16x16x32_bf16 v[72:75], a[80:83], a[44:47], v[72:75]
  ds_read_b64_tr_b16 a[74:75], v138 offset:53248
  v_mfma_f32_16x16x32_bf16 v[44:47], a[84:87], a[36:39], v[44:47]
  ds_read_b64_tr_b16 a[76:77], v139 offset:49152
  v_mfma_f32_16x16x32_bf16 v[76:79], a[84:87], a[44:47], v[76:79]
  ds_read_b64_tr_b16 a[78:79], v139 offset:53248
  s_waitcnt lgkmcnt(8)
  v_mfma_f32_16x16x32_bf16 v[48:51], a[88:91], a[36:39], v[48:51]
  ds_read_b64_tr_b16 a[80:81], v140 offset:49152
  v_mfma_f32_16x16x32_bf16 v[80:83], a[88:91], a[44:47], v[80:83]
  ds_read_b64_tr_b16 a[82:83], v140 offset:53248
  v_mfma_f32_16x16x32_bf16 v[52:55], a[92:95], a[36:39], v[52:55]
  ds_read_b64_tr_b16 a[84:85], v141 offset:49152
  v_mfma_f32_16x16x32_bf16 v[84:87], a[92:95], a[44:47], v[84:87]
  ds_read_b64_tr_b16 a[86:87], v141 offset:53248
  s_waitcnt vmcnt(4)
  s_barrier
  s_waitcnt lgkmcnt(8)
  v_mfma_f32_16x16x32_bf16 v[24:27], a[64:67], a[48:51], v[24:27]
  ds_read_b64_tr_b16 a[88:89], v142 offset:49152
  v_mfma_f32_16x16x32_bf16 v[56:59], a[64:67], a[56:59], v[56:59]
  ds_read_b64_tr_b16 a[90:91], v142 offset:53248
  v_mfma_f32_16x16x32_bf16 v[28:31], a[68:71], a[48:51], v[28:31]
  ds_read_b64_tr_b16 a[92:93], v143 offset:49152
  v_mfma_f32_16x16x32_bf16 v[60:63], a[68:71], a[56:59], v[60:63]
  ds_read_b64_tr_b16 a[94:95], v143 offset:53248
  s_waitcnt lgkmcnt(8)
  v_mfma_f32_16x16x32_bf16 v[32:35], a[72:75], a[48:51], v[32:35]
  ds_read_b64_tr_b16 a[64:65], v136 offset:57344
  v_mfma_f32_16x16x32_bf16 v[64:67], a[72:75], a[56:59], v[64:67]
  ds_read_b64_tr_b16 a[66:67], v136 offset:61440
  v_mfma_f32_16x16x32_bf16 v[36:39], a[76:79], a[48:51], v[36:39]
  ds_read_b64_tr_b16 a[68:69], v137 offset:57344
  v_mfma_f32_16x16x32_bf16 v[68:71], a[76:79], a[56:59], v[68:71]
  ds_read_b64_tr_b16 a[70:71], v137 offset:61440
  s_waitcnt lgkmcnt(8)
  v_mfma_f32_16x16x32_bf16 v[40:43], a[80:83], a[48:51], v[40:43]
  ds_read_b64_tr_b16 a[72:73], v138 offset:57344
  v_mfma_f32_16x16x32_bf16 v[72:75], a[80:83], a[56:59], v[72:75]
  ds_read_b64_tr_b16 a[74:75], v138 offset:61440
  v_mfma_f32_16x16x32_bf16 v[44:47], a[84:87], a[48:51], v[44:47]
  ds_read_b64_tr_b16 a[76:77], v139 offset:57344
  v_mfma_f32_16x16x32_bf16 v[76:79], a[84:87], a[56:59], v[76:79]
  ds_read_b64_tr_b16 a[78:79], v139 offset:61440
  s_waitcnt lgkmcnt(8)
  v_mfma_f32_16x16x32_bf16 v[48:51], a[88:91], a[48:51], v[48:51]
  ds_read_b64_tr_b16 a[80:81], v140 offset:57344
  v_mfma_f32_16x16x32_bf16 v[80:83], a[88:91], a[56:59], v[80:83]
  ds_read_b64_tr_b16 a[82:83], v140 offset:61440
  v_mfma_f32_16x16x32_bf16 v[52:55], a[92:95], a[48:51], v[52:55]
  ds_read_b64_tr_b16 a[84:85], v141 offset:57344
  v_mfma_f32_16x16x32_bf16 v[84:87], a[92:95], a[56:59], v[84:87]
  ds_read_b64_tr_b16 a[86:87], v141 offset:61440
  s_waitcnt lgkmcnt(8)
  v_mfma_f32_16x16x32_bf16 v[24:27], a[64:67], a[52:55], v[24:27]
  ds_read_b64_tr_b16 a[88:89], v142 offset:57344
  v_mfma_f32_16x16x32_bf16 v[56:59], a[64:67], a[60:63], v[56:59]
  ds_read_b64_tr_b16 a[90:91], v142 offset:61440
  v_mfma_f32_16x16x32_bf16 v[28:31], a[68:71], a[52:55], v[28:31]
  ds_read_b64_tr_b16 a[92:93], v143 offset:57344
  v_mfma_f32_16x16x32_bf16 v[60:63], a[68:71], a[60:63], v[60:63]
  ds_read_b64_tr_b16 a[94:95], v143 offset:61440
  s_waitcnt lgkmcnt(8)
  v_mfma_f32_16x16x32_bf16 v[32:35], a[72:75], a[52:55], v[32:35]
  v_mfma_f32_16x16x32_bf16 v[64:67], a[72:75], a[60:63], v[64:67]
  v_mfma_f32_16x16x32_bf16 v[36:39], a[76:79], a[52:55], v[36:39]
  v_mfma_f32_16x16x32_bf16 v[68:71], a[76:79], a[60:63], v[68:71]
  s_waitcnt lgkmcnt(4)
  v_mfma_f32_16x16x32_bf16 v[40:43], a[80:83], a[52:55], v[40:43]
  v_mfma_f32_16x16x32_bf16 v[72:75], a[80:83], a[60:63], v[72:75]
  v_mfma_f32_16x16x32_bf16 v[44:47], a[84:87], a[52:55], v[44:47]
  v_mfma_f32_16x16x32_bf16 v[76:79], a[84:87], a[60:63], v[76:79]
  s_waitcnt lgkmcnt(0)
  v_mfma_f32_16x16x32_bf16 v[48:51], a[88:91], a[52:55], v[48:51]
  v_mfma_f32_16x16x32_bf16 v[80:83], a[88:91], a[60:63], v[80:83]
  v_mfma_f32_16x16x32_bf16 v[52:55], a[92:95], a[52:55], v[52:55]
  v_mfma_f32_16x16x32_bf16 v[84:87], a[92:95], a[60:63], v[84:87]
  s_nop 7
  s_waitcnt vmcnt(0) lgkmcnt(0)
  s_add_u32 s52, s6, 41943040
  s_addc_u32 s53, s7, 0
  s_mov_b32 s54, 4194304
  s_mov_b32 s55, 0x00020000
  s_lshl_b32 s60, s2, 2
  s_add_u32 s60, s60, s23
  s_xor_b32 s61, s60, 4
  s_lshl_b32 s62, s60, 12
  s_lshl_b32 s63, s61, 12
  s_mul_i32 s64, s23, 8704
  v_and_b32 v11, 15, v0
  v_mul_u32_u24 v11, 272, v11
  v_lshrrev_b32 v13, 4, v0
  v_lshl_add_u32 v11, v13, 4, v11
  v_add_u32 v11, s64, v11
  v_lshrrev_b32 v12, 3, v0
  v_mul_u32_u24 v12, 272, v12
  v_and_b32 v13, 7, v0
  v_lshl_add_u32 v12, v13, 5, v12
  v_add_u32 v12, s64, v12
  s_barrier
  s_cmp_eq_u32 s33, 0
  s_cbranch_scc0 L_k3_kh1
  v_cvt_pk_bf16_f32 v120, v40, v41
  v_cvt_pk_bf16_f32 v121, v42, v43
  v_cvt_pk_bf16_f32 v122, v44, v45
  v_cvt_pk_bf16_f32 v123, v46, v47
  v_cvt_pk_bf16_f32 v124, v48, v49
  v_cvt_pk_bf16_f32 v125, v50, v51
  v_cvt_pk_bf16_f32 v126, v52, v53
  v_cvt_pk_bf16_f32 v127, v54, v55
  v_cvt_pk_bf16_f32 v128, v72, v73
  v_cvt_pk_bf16_f32 v129, v74, v75
  v_cvt_pk_bf16_f32 v130, v76, v77
  v_cvt_pk_bf16_f32 v131, v78, v79
  v_cvt_pk_bf16_f32 v132, v80, v81
  v_cvt_pk_bf16_f32 v133, v82, v83
  v_cvt_pk_bf16_f32 v134, v84, v85
  v_cvt_pk_bf16_f32 v135, v86, v87
  buffer_store_dwordx4 v[120:123], v1, s[52:55], s62 offen offset:0 sc1
  buffer_store_dwordx4 v[124:127], v1, s[52:55], s62 offen offset:1024 sc1
  buffer_store_dwordx4 v[128:131], v1, s[52:55], s62 offen offset:2048 sc1
  buffer_store_dwordx4 v[132:135], v1, s[52:55], s62 offen offset:3072 sc1
  s_mov_b32 s67, 100000
L_k3_xp0:
  buffer_load_dwordx4 v[104:107], v1, s[52:55], s63 offen offset:0 sc1
  buffer_load_dwordx4 v[108:111], v1, s[52:55], s63 offen offset:1024 sc1
  buffer_load_dwordx4 v[112:115], v1, s[52:55], s63 offen offset:2048 sc1
  buffer_load_dwordx4 v[116:119], v1, s[52:55], s63 offen offset:3072 sc1
  s_waitcnt vmcnt(0)
  v_max3_u32 v13, v104, v105, v106
  v_max3_u32 v14, v107, v108, v109
  v_max3_u32 v13, v13, v110, v111
  v_max3_u32 v14, v14, v112, v113
  v_max3_u32 v13, v13, v114, v115
  v_max3_u32 v14, v14, v116, v117
  v_max3_u32 v13, v13, v118, v119
  v_max_u32 v13, v13, v14
  v_cmp_eq_u32 vcc, -1, v13
  s_sub_u32 s67, s67, 1
  s_cmp_eq_u32 s67, 0
  s_cbranch_scc1 L_k3_xd0
  s_cbranch_vccnz L_k3_xp0
L_k3_xd0:
  v_lshlrev_b32 v120, 16, v104
  v_and_b32 v121, 0xffff0000, v104
  v_lshlrev_b32 v122, 16, v105
  v_and_b32 v123, 0xffff0000, v105
  v_pk_add_f32 v[24:25], v[24:25], v[120:121]
  v_pk_add_f32 v[26:27], v[26:27], v[122:123]
  ds_write_b128 v11, v[24:27] offset:0
  v_lshlrev_b32 v120, 16, v106
  v_and_b32 v121, 0xffff0000, v106
  v_lshlrev_b32 v122, 16, v107
  v_and_b32 v123, 0xffff0000, v107
  v_pk_add_f32 v[28:29], v[28:29], v[120:121]
  v_pk_add_f32 v[30:31], v[30:31], v[122:123]
  ds_write_b128 v11, v[28:31] offset:64
  v_lshlrev_b32 v120, 16, v108
  v_and_b32 v121, 0xffff0000, v108
  v_lshlrev_b32 v122, 16, v109
  v_and_b32 v123, 0xffff0000, v109
  v_pk_add_f32 v[32:33], v[32:33], v[120:121]
  v_pk_add_f32 v[34:35], v[34:35], v[122:123]
  ds_write_b128 v11, v[32:35] offset:128
  v_lshlrev_b32 v120, 16, v110
  v_and_b32 v121, 0xffff0000, v110
  v_lshlrev_b32 v122, 16, v111
  v_and_b32 v123, 0xffff0000, v111
  v_pk_add_f32 v[36:37], v[36:37], v[120:121]
  v_pk_add_f32 v[38:39], v[38:39], v[122:123]
  ds_write_b128 v11, v[36:39] offset:192
  v_lshlrev_b32 v120, 16, v112
  v_and_b32 v121, 0xffff0000, v112
  v_lshlrev_b32 v122, 16, v113
  v_and_b32 v123, 0xffff0000, v113
  v_pk_add_f32 v[56:57], v[56:57], v[120:121]
  v_pk_add_f32 v[58:59], v[58:59], v[122:123]
  ds_write_b128 v11, v[56:59] offset:4352
  v_lshlrev_b32 v120, 16, v114
  v_and_b32 v121, 0xffff0000, v114
  v_lshlrev_b32 v122, 16, v115
  v_and_b32 v123, 0xffff0000, v115
  v_pk_add_f32 v[60:61], v[60:61], v[120:121]
  v_pk_add_f32 v[62:63], v[62:63], v[122:123]
  ds_write_b128 v11, v[60:63] offset:4416
  v_lshlrev_b32 v120, 16, v116
  v_and_b32 v121, 0xffff0000, v116
  v_lshlrev_b32 v122, 16, v117
  v_and_b32 v123, 0xffff0000, v117
  v_pk_add_f32 v[64:65], v[64:65], v[120:121]
  v_pk_add_f32 v[66:67], v[66:67], v[122:123]
  ds_write_b128 v11, v[64:67] offset:4480
  v_lshlrev_b32 v120, 16, v118
  v_and_b32 v121, 0xffff0000, v118
  v_lshlrev_b32 v122, 16, v119
  v_and_b32 v123, 0xffff0000, v119
  v_pk_add_f32 v[68:69], v[68:69], v[120:121]
  v_pk_add_f32 v[70:71], v[70:71], v[122:123]
  ds_write_b128 v11, v[68:71] offset:4544
  s_branch L_k3_fin
L_k3_kh1:
  v_cvt_pk_bf16_f32 v120, v24, v25
  v_cvt_pk_bf16_f32 v121, v26, v27
  v_cvt_pk_bf16_f32 v122, v28, v29
  v_cvt_pk_bf16_f32 v123, v30, v31
  v_cvt_pk_bf16_f32 v124, v32, v33
  v_cvt_pk_bf16_f32 v125, v34, v35
  v_cvt_pk_bf16_f32 v126, v36, v37
  v_cvt_pk_bf16_f32 v127, v38, v39
  v_cvt_pk_bf16_f32 v128, v56, v57
  v_cvt_pk_bf16_f32 v129, v58, v59
  v_cvt_pk_bf16_f32 v130, v60, v61
  v_cvt_pk_bf16_f32 v131, v62, v63
  v_cvt_pk_bf16_f32 v132, v64, v65
  v_cvt_pk_bf16_f32 v133, v66, v67
  v_cvt_pk_bf16_f32 v134, v68, v69
  v_cvt_pk_bf16_f32 v135, v70, v71
  buffer_store_dwordx4 v[120:123], v1, s[52:55], s62 offen offset:0 sc1
  buffer_store_dwordx4 v[124:127], v1, s[52:55], s62 offen offset:1024 sc1
  buffer_store_dwordx4 v[128:131], v1, s[52:55], s62 offen offset:2048 sc1
  buffer_store_dwordx4 v[132:135], v1, s[52:55], s62 offen offset:3072 sc1
  s_mov_b32 s67, 100000
L_k3_xp1:
  buffer_load_dwordx4 v[104:107], v1, s[52:55], s63 offen offset:0 sc1
  buffer_load_dwordx4 v[108:111], v1, s[52:55], s63 offen offset:1024 sc1
  buffer_load_dwordx4 v[112:115], v1, s[52:55], s63 offen offset:2048 sc1
  buffer_load_dwordx4 v[116:119], v1, s[52:55], s63 offen offset:3072 sc1
  s_waitcnt vmcnt(0)
  v_max3_u32 v13, v104, v105, v106
  v_max3_u32 v14, v107, v108, v109
  v_max3_u32 v13, v13, v110, v111
  v_max3_u32 v14, v14, v112, v113
  v_max3_u32 v13, v13, v114, v115
  v_max3_u32 v14, v14, v116, v117
  v_max3_u32 v13, v13, v118, v119
  v_max_u32 v13, v13, v14
  v_cmp_eq_u32 vcc, -1, v13
  s_sub_u32 s67, s67, 1
  s_cmp_eq_u32 s67, 0
  s_cbranch_scc1 L_k3_xd1
  s_cbranch_vccnz L_k3_xp1
L_k3_xd1:
  v_lshlrev_b32 v120, 16, v104
  v_and_b32 v121, 0xffff0000, v104
  v_lshlrev_b32 v122, 16, v105
  v_and_b32 v123, 0xffff0000, v105
  v_pk_add_f32 v[40:41], v[40:41], v[120:121]
  v_pk_add_f32 v[42:43], v[42:43], v[122:123]
  ds_write_b128 v11, v[40:43] offset:0
  v_lshlrev_b32 v120, 16, v106
  v_and_b32 v121, 0xffff0000, v106
  v_lshlrev_b32 v122, 16, v107
  v_and_b32 v123, 0xffff0000, v107
  v_pk_add_f32 v[44:45], v[44:45], v[120:121]
  v_pk_add_f32 v[46:47], v[46:47], v[122:123]
  ds_write_b128 v11, v[44:47] offset:64
  v_lshlrev_b32 v120, 16, v108
  v_and_b32 v121, 0xffff0000, v108
  v_lshlrev_b32 v122, 16, v109
  v_and_b32 v123, 0xffff0000, v109
  v_pk_add_f32 v[48:49], v[48:49], v[120:121]
  v_pk_add_f32 v[50:51], v[50:51], v[122:123]
  ds_write_b128 v11, v[48:51] offset:128
  v_lshlrev_b32 v120, 16, v110
  v_and_b32 v121, 0xffff0000, v110
  v_lshlrev_b32 v122, 16, v111
  v_and_b32 v123, 0xffff0000, v111
  v_pk_add_f32 v[52:53], v[52:53], v[120:121]
  v_pk_add_f32 v[54:55], v[54:55], v[122:123]
  ds_write_b128 v11, v[52:55] offset:192
  v_lshlrev_b32 v120, 16, v112
  v_and_b32 v121, 0xffff0000, v112
  v_lshlrev_b32 v122, 16, v113
  v_and_b32 v123, 0xffff0000, v113
  v_pk_add_f32 v[72:73], v[72:73], v[120:121]
  v_pk_add_f32 v[74:75], v[74:75], v[122:123]
  ds_write_b128 v11, v[72:75] offset:4352
  v_lshlrev_b32 v120, 16, v114
  v_and_b32 v121, 0xffff0000, v114
  v_lshlrev_b32 v122, 16, v115
  v_and_b32 v123, 0xffff0000, v115
  v_pk_add_f32 v[76:77], v[76:77], v[120:121]
  v_pk_add_f32 v[78:79], v[78:79], v[122:123]
  ds_write_b128 v11, v[76:79] offset:4416
  v_lshlrev_b32 v120, 16, v116
  v_and_b32 v121, 0xffff0000, v116
  v_lshlrev_b32 v122, 16, v117
  v_and_b32 v123, 0xffff0000, v117
  v_pk_add_f32 v[80:81], v[80:81], v[120:121]
  v_pk_add_f32 v[82:83], v[82:83], v[122:123]
  ds_write_b128 v11, v[80:83] offset:4480
  v_lshlrev_b32 v120, 16, v118
  v_and_b32 v121, 0xffff0000, v118
  v_lshlrev_b32 v122, 16, v119
  v_and_b32 v123, 0xffff0000, v119
  v_pk_add_f32 v[84:85], v[84:85], v[120:121]
  v_pk_add_f32 v[86:87], v[86:87], v[122:123]
  ds_write_b128 v11, v[84:87] offset:4544
L_k3_fin:
  s_waitcnt lgkmcnt(0)
  ds_read_b128 v[24:27], v12 offset:0
  ds_read_b128 v[28:31], v12 offset:16
  ds_read_b128 v[32:35], v12 offset:2176
  ds_read_b128 v[36:39], v12 offset:2192
  ds_read_b128 v[40:43], v12 offset:4352
  ds_read_b128 v[44:47], v12 offset:4368
  ds_read_b128 v[48:51], v12 offset:6528
  ds_read_b128 v[52:55], v12 offset:6544
  v_lshlrev_b32 v104, 16, v88
  v_and_b32 v105, 0xffff0000, v88
  v_lshlrev_b32 v106, 16, v89
  v_and_b32 v107, 0xffff0000, v89
  v_lshlrev_b32 v108, 16, v90
  v_and_b32 v109, 0xffff0000, v90
  v_lshlrev_b32 v110, 16, v91
  v_and_b32 v111, 0xffff0000, v91
  s_waitcnt lgkmcnt(6)
  v_pk_add_f32 v[24:25], v[24:25], v[104:105]
  v_pk_add_f32 v[26:27], v[26:27], v[106:107]
  v_pk_add_f32 v[28:29], v[28:29], v[108:109]
  v_pk_add_f32 v[30:31], v[30:31], v[110:111]
  v_cvt_pk_bf16_f32 v24, v24, v25
  v_cvt_pk_bf16_f32 v25, v26, v27
  v_cvt_pk_bf16_f32 v26, v28, v29
  v_cvt_pk_bf16_f32 v27, v30, v31
  buffer_store_dwordx4 v[24:27], v9, s[44:47], s92 offen nt
  v_lshlrev_b32 v104, 16, v92
  v_and_b32 v105, 0xffff0000, v92
  v_lshlrev_b32 v106, 16, v93
  v_and_b32 v107, 0xffff0000, v93
  v_lshlrev_b32 v108, 16, v94
  v_and_b32 v109, 0xffff0000, v94
  v_lshlrev_b32 v110, 16, v95
  v_and_b32 v111, 0xffff0000, v95
  s_waitcnt lgkmcnt(4)
  v_pk_add_f32 v[32:33], v[32:33], v[104:105]
  v_pk_add_f32 v[34:35], v[34:35], v[106:107]
  v_pk_add_f32 v[36:37], v[36:37], v[108:109]
  v_pk_add_f32 v[38:39], v[38:39], v[110:111]
  v_cvt_pk_bf16_f32 v32, v32, v33
  v_cvt_pk_bf16_f32 v33, v34, v35
  v_cvt_pk_bf16_f32 v34, v36, v37
  v_cvt_pk_bf16_f32 v35, v38, v39
  buffer_store_dwordx4 v[32:35], v9, s[44:47], s93 offen nt
  v_lshlrev_b32 v104, 16, v96
  v_and_b32 v105, 0xffff0000, v96
  v_lshlrev_b32 v106, 16, v97
  v_and_b32 v107, 0xffff0000, v97
  v_lshlrev_b32 v108, 16, v98
  v_and_b32 v109, 0xffff0000, v98
  v_lshlrev_b32 v110, 16, v99
  v_and_b32 v111, 0xffff0000, v99
  s_waitcnt lgkmcnt(2)
  v_pk_add_f32 v[40:41], v[40:41], v[104:105]
  v_pk_add_f32 v[42:43], v[42:43], v[106:107]
  v_pk_add_f32 v[44:45], v[44:45], v[108:109]
  v_pk_add_f32 v[46:47], v[46:47], v[110:111]
  v_cvt_pk_bf16_f32 v40, v40, v41
  v_cvt_pk_bf16_f32 v41, v42, v43
  v_cvt_pk_bf16_f32 v42, v44, v45
  v_cvt_pk_bf16_f32 v43, v46, v47
  buffer_store_dwordx4 v[40:43], v9, s[44:47], s94 offen nt
  v_lshlrev_b32 v104, 16, v100
  v_and_b32 v105, 0xffff0000, v100
  v_lshlrev_b32 v106, 16, v101
  v_and_b32 v107, 0xffff0000, v101
  v_lshlrev_b32 v108, 16, v102
  v_and_b32 v109, 0xffff0000, v102
  v_lshlrev_b32 v110, 16, v103
  v_and_b32 v111, 0xffff0000, v103
  s_waitcnt lgkmcnt(0)
  v_pk_add_f32 v[48:49], v[48:49], v[104:105]
  v_pk_add_f32 v[50:51], v[50:51], v[106:107]
  v_pk_add_f32 v[52:53], v[52:53], v[108:109]
  v_pk_add_f32 v[54:55], v[54:55], v[110:111]
  v_cvt_pk_bf16_f32 v48, v48, v49
  v_cvt_pk_bf16_f32 v49, v50, v51
  v_cvt_pk_bf16_f32 v50, v52, v53
  v_cvt_pk_bf16_f32 v51, v54, v55
  buffer_store_dwordx4 v[48:51], v9, s[44:47], s95 offen nt
L_k3_end:
  s_endpgm
L_k3_helper:
  s_and_b32 s50, s2, 31
  s_lshr_b32 s51, s2, 5
  s_and_b32 s51, s51, 7
  s_add_u32 s52, s6, 33554432
  s_addc_u32 s53, s7, 0
  s_mov_b32 s54, 1048576
  s_mov_b32 s55, 0x00020000
  s_add_u32 s56, s6, 36700160
  s_addc_u32 s57, s7, 0
  s_mov_b32 s58, 65536
  s_mov_b32 s59, 0x00020000
  s_add_u32 s60, s6, 25165824
  s_addc_u32 s61, s7, 0
  s_mov_b32 s62, 4194304
  s_mov_b32 s63, 0x00020000
  s_lshl_b32 s64, s50, 15
  s_lshl_b32 s65, s23, 10
  s_add_u32 s64, s64, s65
  s_lshl_b32 s66, s50, 11
  s_lshl_b32 s65, s23, 6
  s_add_u32 s66, s66, s65
  s_lshl_b32 s65, s51, 4
  s_lshl_b32 s67, s23, 2
  s_add_u32 s65, s65, s67
  s_lshl_b32 s67, s50, 17
  s_lshl_b32 s75, s65, 10
  s_add_u32 s67, s67, s75
  v_lshrrev_b32 v11, 4, v0
  v_lshlrev_b32 v11, 4, v11
  v_and_b32 v12, 7, v0
  v_lshl_add_u32 v12, v12, 8, v11
  buffer_load_dwordx4 v[24:27], v1, s[52:55], s64 offen
  s_add_u32 s64, s64, 4096
  buffer_load_dwordx4 v[28:31], v1, s[52:55], s64 offen
  s_add_u32 s64, s64, 4096
  buffer_load_dwordx4 v[32:35], v1, s[52:55], s64 offen
  s_add_u32 s64, s64, 4096
  buffer_load_dwordx4 v[36:39], v1, s[52:55], s64 offen
  s_add_u32 s64, s64, 4096
  buffer_load_dwordx4 v[40:43], v1, s[52:55], s64 offen
  s_add_u32 s64, s64, 4096
  buffer_load_dwordx4 v[44:47], v1, s[52:55], s64 offen
  s_add_u32 s64, s64, 4096
  buffer_load_dwordx4 v[48:51], v1, s[52:55], s64 offen
  s_add_u32 s64, s64, 4096
  buffer_load_dwordx4 v[52:55], v1, s[52:55], s64 offen
  buffer_load_dwordx4 v[56:59], v12, s[56:59], s66 offen
  buffer_load_dwordx4 v[60:63], v1, s[60:63], s67 offen offset:0
  buffer_load_dwordx4 v[64:67], v1, s[60:63], s67 offen offset:1024
  buffer_load_dwordx4 v[68:71], v1, s[60:63], s67 offen offset:2048
  buffer_load_dwordx4 v[72:75], v1, s[60:63], s67 offen offset:3072
  s_waitcnt vmcnt(4)
  s_mov_b32 s75, 0xffff0000
  v_lshlrev_b32 v76, 16, v24
  v_and_b32 v77, s75, v24
  v_lshlrev_b32 v78, 16, v25
  v_and_b32 v79, s75, v25
  v_lshlrev_b32 v80, 16, v26
  v_and_b32 v81, s75, v26
  v_lshlrev_b32 v82, 16, v27
  v_and_b32 v83, s75, v27
  v_lshlrev_b32 v84, 16, v28
  v_and_b32 v85, s75, v28
  v_lshlrev_b32 v86, 16, v29
  v_and_b32 v87, s75, v29
  v_lshlrev_b32 v88, 16, v30
  v_and_b32 v89, s75, v30
  v_lshlrev_b32 v90, 16, v31
  v_and_b32 v91, s75, v31
  v_pk_add_f32 v[76:77], v[76:77], v[84:85]
  v_pk_add_f32 v[78:79], v[78:79], v[86:87]
  v_pk_add_f32 v[80:81], v[80:81], v[88:89]
  v_pk_add_f32 v[82:83], v[82:83], v[90:91]
  v_lshlrev_b32 v84, 16, v32
  v_and_b32 v85, s75, v32
  v_lshlrev_b32 v86, 16, v33
  v_and_b32 v87, s75, v33
  v_lshlrev_b32 v88, 16, v34
  v_and_b32 v89, s75, v34
  v_lshlrev_b32 v90, 16, v35
  v_and_b32 v91, s75, v35
  v_pk_add_f32 v[76:77], v[76:77], v[84:85]
  v_pk_add_f32 v[78:79], v[78:79], v[86:87]
  v_pk_add_f32 v[80:81], v[80:81], v[88:89]
  v_pk_add_f32 v[82:83], v[82:83], v[90:91]
  v_lshlrev_b32 v84, 16, v36
  v_and_b32 v85, s75, v36
  v_lshlrev_b32 v86, 16, v37
  v_and_b32 v87, s75, v37
  v_lshlrev_b32 v88, 16, v38
  v_and_b32 v89, s75, v38
  v_lshlrev_b32 v90, 16, v39
  v_and_b32 v91, s75, v39
  v_pk_add_f32 v[76:77], v[76:77], v[84:85]
  v_pk_add_f32 v[78:79], v[78:79], v[86:87]
  v_pk_add_f32 v[80:81], v[80:81], v[88:89]
  v_pk_add_f32 v[82:83], v[82:83], v[90:91]
  v_lshlrev_b32 v84, 16, v40
  v_and_b32 v85, s75, v40
  v_lshlrev_b32 v86, 16, v41
  v_and_b32 v87, s75, v41
  v_lshlrev_b32 v88, 16, v42
  v_and_b32 v89, s75, v42
  v_lshlrev_b32 v90, 16, v43
  v_and_b32 v91, s75, v43
  v_pk_add_f32 v[76:77], v[76:77], v[84:85]
  v_pk_add_f32 v[78:79], v[78:79], v[86:87]
  v_pk_add_f32 v[80:81], v[80:81], v[88:89]
  v_pk_add_f32 v[82:83], v[82:83], v[90:91]
  v_lshlrev_b32 v84, 16, v44
  v_and_b32 v85, s75, v44
  v_lshlrev_b32 v86, 16, v45
  v_and_b32 v87, s75, v45
  v_lshlrev_b32 v88, 16, v46
  v_and_b32 v89, s75, v46
  v_lshlrev_b32 v90, 16, v47
  v_and_b32 v91, s75, v47
  v_pk_add_f32 v[76:77], v[76:77], v[84:85]
  v_pk_add_f32 v[78:79], v[78:79], v[86:87]
  v_pk_add_f32 v[80:81], v[80:81], v[88:89]
  v_pk_add_f32 v[82:83], v[82:83], v[90:91]
  v_lshlrev_b32 v84, 16, v48
  v_and_b32 v85, s75, v48
  v_lshlrev_b32 v86, 16, v49
  v_and_b32 v87, s75, v49
  v_lshlrev_b32 v88, 16, v50
  v_and_b32 v89, s75, v50
  v_lshlrev_b32 v90, 16, v51
  v_and_b32 v91, s75, v51
  v_pk_add_f32 v[76:77], v[76:77], v[84:85]
  v_pk_add_f32 v[78:79], v[78:79], v[86:87]
  v_pk_add_f32 v[80:81], v[80:81], v[88:89]
  v_pk_add_f32 v[82:83], v[82:83], v[90:91]
  v_lshlrev_b32 v84, 16, v52
  v_and_b32 v85, s75, v52
  v_lshlrev_b32 v86, 16, v53
  v_and_b32 v87, s75, v53
  v_lshlrev_b32 v88, 16, v54
  v_and_b32 v89, s75, v54
  v_lshlrev_b32 v90, 16, v55
  v_and_b32 v91, s75, v55
  v_pk_add_f32 v[76:77], v[76:77], v[84:85]
  v_pk_add_f32 v[78:79], v[78:79], v[86:87]
  v_pk_add_f32 v[80:81], v[80:81], v[88:89]
  v_pk_add_f32 v[82:83], v[82:83], v[90:91]
  v_cvt_pk_bf16_f32 v24, v76, v77
  v_cvt_pk_bf16_f32 v25, v78, v79
  v_cvt_pk_bf16_f32 v26, v80, v81
  v_cvt_pk_bf16_f32 v27, v82, v83
  s_nop 0
  v_add_f32_dpp v56, v56, v56 row_ror:1 row_mask:0xf bank_mask:0xf
  v_add_f32_dpp v57, v57, v57 row_ror:1 row_mask:0xf bank_mask:0xf
  v_add_f32_dpp v58, v58, v58 row_ror:1 row_mask:0xf bank_mask:0xf
  v_add_f32_dpp v59, v59, v59 row_ror:1 row_mask:0xf bank_mask:0xf
  s_nop 0
  v_add_f32_dpp v56, v56, v56 row_ror:2 row_mask:0xf bank_mask:0xf
  v_add_f32_dpp v57, v57, v57 row_ror:2 row_mask:0xf bank_mask:0xf
  v_add_f32_dpp v58, v58, v58 row_ror:2 row_mask:0xf bank_mask:0xf
  v_add_f32_dpp v59, v59, v59 row_ror:2 row_mask:0xf bank_mask:0xf
  s_nop 0
  v_add_f32_dpp v56, v56, v56 row_ror:4 row_mask:0xf bank_mask:0xf
  v_add_f32_dpp v57, v57, v57 row_ror:4 row_mask:0xf bank_mask:0xf
  v_add_f32_dpp v58, v58, v58 row_ror:4 row_mask:0xf bank_mask:0xf
  v_add_f32_dpp v59, v59, v59 row_ror:4 row_mask:0xf bank_mask:0xf
  s_lshl_b32 s75, s23, 10
  s_add_u32 s75, s75, 65536
  v_add_u32 v12, s75, v1
  ds_write_b128 v12, v[24:27]
  s_lshl_b32 s75, s23, 6
  s_add_u32 s75, s75, 69632
  v_add_u32 v13, s75, v11
  ds_write_b128 v13, v[56:59]
  s_waitcnt vmcnt(0)
  s_mov_b32 s80, 1069066811
  s_mov_b32 s81, 1069066811
  s_mov_b32 s82, 3216550459
  s_mov_b32 s83, 3216550459
  s_mov_b32 s75, 0xffff0000
  v_lshlrev_b32 v76, 16, v60
  v_and_b32 v77, s75, v60
  v_lshlrev_b32 v78, 16, v61
  v_and_b32 v79, s75, v61
  v_lshlrev_b32 v80, 16, v62
  v_and_b32 v81, s75, v62
  v_lshlrev_b32 v82, 16, v63
  v_and_b32 v83, s75, v63
  v_lshlrev_b32 v84, 16, v64
  v_and_b32 v85, s75, v64
  v_lshlrev_b32 v86, 16, v65
  v_and_b32 v87, s75, v65
  v_lshlrev_b32 v88, 16, v66
  v_and_b32 v89, s75, v66
  v_lshlrev_b32 v90, 16, v67
  v_and_b32 v91, s75, v67
  v_lshlrev_b32 v92, 16, v68
  v_and_b32 v93, s75, v68
  v_lshlrev_b32 v94, 16, v69
  v_and_b32 v95, s75, v69
  v_lshlrev_b32 v96, 16, v70
  v_and_b32 v97, s75, v70
  v_lshlrev_b32 v98, 16, v71
  v_and_b32 v99, s75, v71
  v_lshlrev_b32 v100, 16, v72
  v_and_b32 v101, s75, v72
  v_lshlrev_b32 v102, 16, v73
  v_and_b32 v103, s75, v73
  v_lshlrev_b32 v104, 16, v74
  v_and_b32 v105, s75, v74
  v_lshlrev_b32 v106, 16, v75
  v_and_b32 v107, s75, v75
  v_max3_f32 v140, v76, v77, v78
  v_max3_f32 v141, -v76, -v77, -v78
  v_max3_f32 v140, v140, v79, v80
  v_max3_f32 v141, v141, -v79, -v80
  v_max3_f32 v140, v140, v81, v82
  v_max3_f32 v141, v141, -v81, -v82
  v_max_f32 v140, v140, v83
  v_max3_f32 v141, v141, -v83, -v83
  v_max3_f32 v144, v84, v85, v86
  v_max3_f32 v145, -v84, -v85, -v86
  v_max3_f32 v144, v144, v87, v88
  v_max3_f32 v145, v145, -v87, -v88
  v_max3_f32 v144, v144, v89, v90
  v_max3_f32 v145, v145, -v89, -v90
  v_max_f32 v144, v144, v91
  v_max3_f32 v145, v145, -v91, -v91
  v_max3_f32 v148, v92, v93, v94
  v_max3_f32 v149, -v92, -v93, -v94
  v_max3_f32 v148, v148, v95, v96
  v_max3_f32 v149, v149, -v95, -v96
  v_max3_f32 v148, v148, v97, v98
  v_max3_f32 v149, v149, -v97, -v98
  v_max_f32 v148, v148, v99
  v_max3_f32 v149, v149, -v99, -v99
  v_max3_f32 v152, v100, v101, v102
  v_max3_f32 v153, -v100, -v101, -v102
  v_max3_f32 v152, v152, v103, v104
  v_max3_f32 v153, v153, -v103, -v104
  v_max3_f32 v152, v152, v105, v106
  v_max3_f32 v153, v153, -v105, -v106
  v_max_f32 v152, v152, v107
  v_max3_f32 v153, v153, -v107, -v107
  s_nop 0
  v_permlane16_swap_b32 v140, v141
  v_permlane16_swap_b32 v144, v145
  v_permlane16_swap_b32 v148, v149
  v_permlane16_swap_b32 v152, v153
  v_max_f32 v140, v140, v141
  v_mov_b32 v142, v140
  v_max_f32 v144, v144, v145
  v_mov_b32 v146, v144
  v_max_f32 v148, v148, v149
  v_mov_b32 v150, v148
  v_max_f32 v152, v152, v153
  v_mov_b32 v154, v152
  v_permlane32_swap_b32 v140, v142
  v_permlane32_swap_b32 v144, v146
  v_permlane32_swap_b32 v148, v150
  s_nop 0
  v_permlane32_swap_b32 v152, v154
  v_max_f32 v140, v140, v142
  v_mov_b32 v142, v140
  v_max_f32 v144, v144, v146
  v_mov_b32 v146, v144
  v_max_f32 v148, v148, v150
  v_mov_b32 v150, v148
  v_max_f32 v152, v152, v154
  v_mov_b32 v154, v152
  v_permlane16_swap_b32 v140, v142
  v_permlane16_swap_b32 v144, v146
  v_permlane16_swap_b32 v148, v150
  s_nop 0
  v_permlane16_swap_b32 v152, v154
  v_mul_f32 v140, s82, v140
  v_mul_f32 v142, s82, v142
  v_mul_f32 v144, s82, v144
  v_mul_f32 v146, s82, v146
  v_mul_f32 v148, s82, v148
  v_mul_f32 v150, s82, v150
  v_mul_f32 v152, s82, v152
  v_mul_f32 v154, s82, v154
  v_pk_fma_f32 v[108:109], v[76:77], s[82:83], v[142:143] op_sel_hi:[1,1,0]
  v_pk_fma_f32 v[110:111], v[78:79], s[82:83], v[142:143] op_sel_hi:[1,1,0]
  v_pk_fma_f32 v[112:113], v[80:81], s[82:83], v[142:143] op_sel_hi:[1,1,0]
  v_pk_fma_f32 v[114:115], v[82:83], s[82:83], v[142:143] op_sel_hi:[1,1,0]
  v_pk_fma_f32 v[76:77], v[76:77], s[80:81], v[140:141] op_sel_hi:[1,1,0]
  v_pk_fma_f32 v[78:79], v[78:79], s[80:81], v[140:141] op_sel_hi:[1,1,0]
  v_pk_fma_f32 v[80:81], v[80:81], s[80:81], v[140:141] op_sel_hi:[1,1,0]
  v_pk_fma_f32 v[82:83], v[82:83], s[80:81], v[140:141] op_sel_hi:[1,1,0]
  v_pk_fma_f32 v[116:117], v[84:85], s[82:83], v[146:147] op_sel_hi:[1,1,0]
  v_pk_fma_f32 v[118:119], v[86:87], s[82:83], v[146:147] op_sel_hi:[1,1,0]
  v_pk_fma_f32 v[120:121], v[88:89], s[82:83], v[146:147] op_sel_hi:[1,1,0]
  v_pk_fma_f32 v[122:123], v[90:91], s[82:83], v[146:147] op_sel_hi:[1,1,0]
  v_pk_fma_f32 v[84:85], v[84:85], s[80:81], v[144:145] op_sel_hi:[1,1,0]
  v_pk_fma_f32 v[86:87], v[86:87], s[80:81], v[144:145] op_sel_hi:[1,1,0]
  v_pk_fma_f32 v[88:89], v[88:89], s[80:81], v[144:145] op_sel_hi:[1,1,0]
  v_pk_fma_f32 v[90:91], v[90:91], s[80:81], v[144:145] op_sel_hi:[1,1,0]
  v_pk_fma_f32 v[124:125], v[92:93], s[82:83], v[150:151] op_sel_hi:[1,1,0]
  v_pk_fma_f32 v[126:127], v[94:95], s[82:83], v[150:151] op_sel_hi:[1,1,0]
  v_pk_fma_f32 v[128:129], v[96:97], s[82:83], v[150:151] op_sel_hi:[1,1,0]
  v_pk_fma_f32 v[130:131], v[98:99], s[82:83], v[150:151] op_sel_hi:[1,1,0]
  v_pk_fma_f32 v[92:93], v[92:93], s[80:81], v[148:149] op_sel_hi:[1,1,0]
  v_pk_fma_f32 v[94:95], v[94:95], s[80:81], v[148:149] op_sel_hi:[1,1,0]
  v_pk_fma_f32 v[96:97], v[96:97], s[80:81], v[148:149] op_sel_hi:[1,1,0]
  v_pk_fma_f32 v[98:99], v[98:99], s[80:81], v[148:149] op_sel_hi:[1,1,0]
  v_pk_fma_f32 v[132:133], v[100:101], s[82:83], v[154:155] op_sel_hi:[1,1,0]
  v_pk_fma_f32 v[134:135], v[102:103], s[82:83], v[154:155] op_sel_hi:[1,1,0]
  v_pk_fma_f32 v[136:137], v[104:105], s[82:83], v[154:155] op_sel_hi:[1,1,0]
  v_pk_fma_f32 v[138:139], v[106:107], s[82:83], v[154:155] op_sel_hi:[1,1,0]
  v_pk_fma_f32 v[100:101], v[100:101], s[80:81], v[152:153] op_sel_hi:[1,1,0]
  v_pk_fma_f32 v[102:103], v[102:103], s[80:81], v[152:153] op_sel_hi:[1,1,0]
  v_pk_fma_f32 v[104:105], v[104:105], s[80:81], v[152:153] op_sel_hi:[1,1,0]
  v_pk_fma_f32 v[106:107], v[106:107], s[80:81], v[152:153] op_sel_hi:[1,1,0]
  v_exp_f32 v76, v76
  v_exp_f32 v108, v108
  v_exp_f32 v77, v77
  v_exp_f32 v109, v109
  v_exp_f32 v78, v78
  v_exp_f32 v110, v110
  v_exp_f32 v79, v79
  v_exp_f32 v111, v111
  v_exp_f32 v80, v80
  v_exp_f32 v112, v112
  v_exp_f32 v81, v81
  v_exp_f32 v113, v113
  v_exp_f32 v82, v82
  v_exp_f32 v114, v114
  v_exp_f32 v83, v83
  v_exp_f32 v115, v115
  v_exp_f32 v84, v84
  v_exp_f32 v116, v116
  v_exp_f32 v85, v85
  v_exp_f32 v117, v117
  v_exp_f32 v86, v86
  v_exp_f32 v118, v118
  v_exp_f32 v87, v87
  v_exp_f32 v119, v119
  v_exp_f32 v88, v88
  v_exp_f32 v120, v120
  v_exp_f32 v89, v89
  v_exp_f32 v121, v121
  v_exp_f32 v90, v90
  v_exp_f32 v122, v122
  v_exp_f32 v91, v91
  v_exp_f32 v123, v123
  v_exp_f32 v92, v92
  v_exp_f32 v124, v124
  v_exp_f32 v93, v93
  v_exp_f32 v125, v125
  v_exp_f32 v94, v94
  v_exp_f32 v126, v126
  v_exp_f32 v95, v95
  v_exp_f32 v127, v127
  v_exp_f32 v96, v96
  v_exp_f32 v128, v128
  v_exp_f32 v97, v97
  v_exp_f32 v129, v129
  v_exp_f32 v98, v98
  v_exp_f32 v130, v130
  v_exp_f32 v99, v99
  v_exp_f32 v131, v131
  v_exp_f32 v100, v100
  v_exp_f32 v132, v132
  v_exp_f32 v101, v101
  v_exp_f32 v133, v133
  v_exp_f32 v102, v102
  v_exp_f32 v134, v134
  v_exp_f32 v103, v103
  v_exp_f32 v135, v135
  v_exp_f32 v104, v104
  v_exp_f32 v136, v136
  v_exp_f32 v105, v105
  v_exp_f32 v137, v137
  v_exp_f32 v106, v106
  v_exp_f32 v138, v138
  v_exp_f32 v107, v107
  v_exp_f32 v139, v139
  v_cvt_pk_bf16_f32 v60, v76, v77
  v_cvt_pk_bf16_f32 v61, v78, v79
  v_cvt_pk_bf16_f32 v62, v80, v81
  v_cvt_pk_bf16_f32 v63, v82, v83
  v_cvt_pk_bf16_f32 v40, v108, v109
  v_cvt_pk_bf16_f32 v41, v110, v111
  v_cvt_pk_bf16_f32 v42, v112, v113
  v_cvt_pk_bf16_f32 v43, v114, v115
  v_cvt_pk_bf16_f32 v64, v84, v85
  v_cvt_pk_bf16_f32 v65, v86, v87
  v_cvt_pk_bf16_f32 v66, v88, v89
  v_cvt_pk_bf16_f32 v67, v90, v91
  v_cvt_pk_bf16_f32 v44, v116, v117
  v_cvt_pk_bf16_f32 v45, v118, v119
  v_cvt_pk_bf16_f32 v46, v120, v121
  v_cvt_pk_bf16_f32 v47, v122, v123
  v_cvt_pk_bf16_f32 v68, v92, v93
  v_cvt_pk_bf16_f32 v69, v94, v95
  v_cvt_pk_bf16_f32 v70, v96, v97
  v_cvt_pk_bf16_f32 v71, v98, v99
  v_cvt_pk_bf16_f32 v48, v124, v125
  v_cvt_pk_bf16_f32 v49, v126, v127
  v_cvt_pk_bf16_f32 v50, v128, v129
  v_cvt_pk_bf16_f32 v51, v130, v131
  v_cvt_pk_bf16_f32 v72, v100, v101
  v_cvt_pk_bf16_f32 v73, v102, v103
  v_cvt_pk_bf16_f32 v74, v104, v105
  v_cvt_pk_bf16_f32 v75, v106, v107
  v_cvt_pk_bf16_f32 v52, v132, v133
  v_cvt_pk_bf16_f32 v53, v134, v135
  v_cvt_pk_bf16_f32 v54, v136, v137
  v_cvt_pk_bf16_f32 v55, v138, v139
  s_waitcnt lgkmcnt(0)
  s_barrier
  v_add_u32 v12, 65536, v1
  ds_read_b128 v[24:27], v12 offset:0
  ds_read_b128 v[28:31], v12 offset:1024
  ds_read_b128 v[32:35], v12 offset:2048
  ds_read_b128 v[36:39], v12 offset:3072
  v_add_u32 v13, 69632, v11
  ds_read_b128 v[76:79], v13 offset:0
  ds_read_b128 v[80:83], v13 offset:64
  ds_read_b128 v[84:87], v13 offset:128
  ds_read_b128 v[88:91], v13 offset:192
  v_and_b32 v12, 3, v0
  v_cmp_eq_u32 vcc, 0, v12
  v_cmp_eq_u32 s[42:43], 1, v12
  v_mov_b32 v13, 0x3f803f80
  s_waitcnt lgkmcnt(0)
  v_cvt_pk_bf16_f32 v76, v76, v77
  v_cvt_pk_bf16_f32 v77, v78, v79
  v_cvt_pk_bf16_f32 v80, v80, v81
  v_cvt_pk_bf16_f32 v81, v82, v83
  v_cvt_pk_bf16_f32 v84, v84, v85
  v_cvt_pk_bf16_f32 v85, v86, v87
  v_cvt_pk_bf16_f32 v88, v88, v89
  v_cvt_pk_bf16_f32 v89, v90, v91
  v_cndmask_b32 v92, 0, v76, vcc
  v_cndmask_b32 v92, v92, v13, s[42:43]
  v_cndmask_b32 v93, 0, v77, vcc
  v_cndmask_b32 v93, v93, v13, s[42:43]
  v_cndmask_b32 v94, 0, v80, vcc
  v_cndmask_b32 v94, v94, v13, s[42:43]
  v_cndmask_b32 v95, 0, v81, vcc
  v_cndmask_b32 v95, v95, v13, s[42:43]
  v_cndmask_b32 v96, 0, v84, vcc
  v_cndmask_b32 v96, v96, v13, s[42:43]
  v_cndmask_b32 v97, 0, v85, vcc
  v_cndmask_b32 v97, v97, v13, s[42:43]
  v_cndmask_b32 v98, 0, v88, vcc
  v_cndmask_b32 v98, v98, v13, s[42:43]
  v_cndmask_b32 v99, 0, v89, vcc
  v_cndmask_b32 v99, v99, v13, s[42:43]
  s_mul_i32 s64, s65, 147456
  s_lshl_b32 s75, s50, 10
  s_add_u32 s64, s64, s75
  v_mov_b32 v13, 0x358637bd
  s_nop 0
  v_mfma_f32_16x16x32_bf16 v[116:119], v[92:95], v[60:63], 0
  v_mfma_f32_16x16x32_bf16 v[120:123], v[96:99], v[40:43], 0
  v_mfma_f32_16x16x32_bf16 v[100:103], v[24:27], v[60:63], 0
  v_mfma_f32_16x16x32_bf16 v[104:107], v[28:31], v[60:63], 0
  v_mfma_f32_16x16x32_bf16 v[108:111], v[32:35], v[40:43], 0
  v_mfma_f32_16x16x32_bf16 v[112:115], v[36:39], v[40:43], 0
  v_mfma_f32_16x16x32_bf16 v[140:143], v[92:95], v[64:67], 0
  v_mfma_f32_16x16x32_bf16 v[144:147], v[96:99], v[44:47], 0
  v_mfma_f32_16x16x32_bf16 v[124:127], v[24:27], v[64:67], 0
  v_mfma_f32_16x16x32_bf16 v[128:131], v[28:31], v[64:67], 0
  v_mfma_f32_16x16x32_bf16 v[132:135], v[32:35], v[44:47], 0
  v_mfma_f32_16x16x32_bf16 v[136:139], v[36:39], v[44:47], 0
  s_nop 3
  v_rcp_f32 v117, v117
  v_rcp_f32 v121, v121
  v_rcp_f32 v141, v141
  v_rcp_f32 v145, v145
  s_nop 0
  v_fma_f32 v118, v116, v117, v13
  v_fma_f32 v118, v120, v121, v118
  v_fma_f32 v142, v140, v141, v13
  v_fma_f32 v142, v144, v145, v142
  v_rcp_f32 v118, v118
  v_rcp_f32 v142, v142
  s_nop 2
  v_mul_f32 v116, v117, v118
  v_mul_f32 v120, v121, v118
  v_mul_f32 v140, v141, v142
  v_mul_f32 v144, v145, v142
  v_pk_mul_f32 v[100:101], v[100:101], v[116:117] op_sel_hi:[1,0]
  v_pk_mul_f32 v[102:103], v[102:103], v[116:117] op_sel_hi:[1,0]
  v_pk_mul_f32 v[104:105], v[104:105], v[116:117] op_sel_hi:[1,0]
  v_pk_mul_f32 v[106:107], v[106:107], v[116:117] op_sel_hi:[1,0]
  v_pk_fma_f32 v[100:101], v[108:109], v[120:121], v[100:101] op_sel_hi:[1,0,1]
  v_pk_fma_f32 v[102:103], v[110:111], v[120:121], v[102:103] op_sel_hi:[1,0,1]
  v_pk_fma_f32 v[104:105], v[112:113], v[120:121], v[104:105] op_sel_hi:[1,0,1]
  v_pk_fma_f32 v[106:107], v[114:115], v[120:121], v[106:107] op_sel_hi:[1,0,1]
  v_pk_mul_f32 v[124:125], v[124:125], v[140:141] op_sel_hi:[1,0]
  v_pk_mul_f32 v[126:127], v[126:127], v[140:141] op_sel_hi:[1,0]
  v_pk_mul_f32 v[128:129], v[128:129], v[140:141] op_sel_hi:[1,0]
  v_pk_mul_f32 v[130:131], v[130:131], v[140:141] op_sel_hi:[1,0]
  v_pk_fma_f32 v[124:125], v[132:133], v[144:145], v[124:125] op_sel_hi:[1,0,1]
  v_pk_fma_f32 v[126:127], v[134:135], v[144:145], v[126:127] op_sel_hi:[1,0,1]
  v_pk_fma_f32 v[128:129], v[136:137], v[144:145], v[128:129] op_sel_hi:[1,0,1]
  v_pk_fma_f32 v[130:131], v[138:139], v[144:145], v[130:131] op_sel_hi:[1,0,1]
  v_cvt_pk_bf16_f32 v148, v100, v101
  v_cvt_pk_bf16_f32 v149, v102, v103
  v_cvt_pk_bf16_f32 v150, v104, v105
  v_cvt_pk_bf16_f32 v151, v106, v107
  buffer_store_dwordx4 v[148:151], v1, s[8:11], s64 offen sc1
  s_add_u32 s64, s64, 147456
  v_cvt_pk_bf16_f32 v152, v124, v125
  v_cvt_pk_bf16_f32 v153, v126, v127
  v_cvt_pk_bf16_f32 v154, v128, v129
  v_cvt_pk_bf16_f32 v155, v130, v131
  buffer_store_dwordx4 v[152:155], v1, s[8:11], s64 offen sc1
  s_add_u32 s64, s64, 147456
  s_nop 1
  v_mfma_f32_16x16x32_bf16 v[116:119], v[92:95], v[68:71], 0
  v_mfma_f32_16x16x32_bf16 v[120:123], v[96:99], v[48:51], 0
  v_mfma_f32_16x16x32_bf16 v[100:103], v[24:27], v[68:71], 0
  v_mfma_f32_16x16x32_bf16 v[104:107], v[28:31], v[68:71], 0
  v_mfma_f32_16x16x32_bf16 v[108:111], v[32:35], v[48:51], 0
  v_mfma_f32_16x16x32_bf16 v[112:115], v[36:39], v[48:51], 0
  v_mfma_f32_16x16x32_bf16 v[140:143], v[92:95], v[72:75], 0
  v_mfma_f32_16x16x32_bf16 v[144:147], v[96:99], v[52:55], 0
  v_mfma_f32_16x16x32_bf16 v[124:127], v[24:27], v[72:75], 0
  v_mfma_f32_16x16x32_bf16 v[128:131], v[28:31], v[72:75], 0
  v_mfma_f32_16x16x32_bf16 v[132:135], v[32:35], v[52:55], 0
  v_mfma_f32_16x16x32_bf16 v[136:139], v[36:39], v[52:55], 0
  s_nop 3
  v_rcp_f32 v117, v117
  v_rcp_f32 v121, v121
  v_rcp_f32 v141, v141
  v_rcp_f32 v145, v145
  s_nop 0
  v_fma_f32 v118, v116, v117, v13
  v_fma_f32 v118, v120, v121, v118
  v_fma_f32 v142, v140, v141, v13
  v_fma_f32 v142, v144, v145, v142
  v_rcp_f32 v118, v118
  v_rcp_f32 v142, v142
  s_nop 2
  v_mul_f32 v116, v117, v118
  v_mul_f32 v120, v121, v118
  v_mul_f32 v140, v141, v142
  v_mul_f32 v144, v145, v142
  v_pk_mul_f32 v[100:101], v[100:101], v[116:117] op_sel_hi:[1,0]
  v_pk_mul_f32 v[102:103], v[102:103], v[116:117] op_sel_hi:[1,0]
  v_pk_mul_f32 v[104:105], v[104:105], v[116:117] op_sel_hi:[1,0]
  v_pk_mul_f32 v[106:107], v[106:107], v[116:117] op_sel_hi:[1,0]
  v_pk_fma_f32 v[100:101], v[108:109], v[120:121], v[100:101] op_sel_hi:[1,0,1]
  v_pk_fma_f32 v[102:103], v[110:111], v[120:121], v[102:103] op_sel_hi:[1,0,1]
  v_pk_fma_f32 v[104:105], v[112:113], v[120:121], v[104:105] op_sel_hi:[1,0,1]
  v_pk_fma_f32 v[106:107], v[114:115], v[120:121], v[106:107] op_sel_hi:[1,0,1]
  v_pk_mul_f32 v[124:125], v[124:125], v[140:141] op_sel_hi:[1,0]
  v_pk_mul_f32 v[126:127], v[126:127], v[140:141] op_sel_hi:[1,0]
  v_pk_mul_f32 v[128:129], v[128:129], v[140:141] op_sel_hi:[1,0]
  v_pk_mul_f32 v[130:131], v[130:131], v[140:141] op_sel_hi:[1,0]
  v_pk_fma_f32 v[124:125], v[132:133], v[144:145], v[124:125] op_sel_hi:[1,0,1]
  v_pk_fma_f32 v[126:127], v[134:135], v[144:145], v[126:127] op_sel_hi:[1,0,1]
  v_pk_fma_f32 v[128:129], v[136:137], v[144:145], v[128:129] op_sel_hi:[1,0,1]
  v_pk_fma_f32 v[130:131], v[138:139], v[144:145], v[130:131] op_sel_hi:[1,0,1]
  v_cvt_pk_bf16_f32 v148, v100, v101
  v_cvt_pk_bf16_f32 v149, v102, v103
  v_cvt_pk_bf16_f32 v150, v104, v105
  v_cvt_pk_bf16_f32 v151, v106, v107
  buffer_store_dwordx4 v[148:151], v1, s[8:11], s64 offen sc1
  s_add_u32 s64, s64, 147456
  v_cvt_pk_bf16_f32 v152, v124, v125
  v_cvt_pk_bf16_f32 v153, v126, v127
  v_cvt_pk_bf16_f32 v154, v128, v129
  v_cvt_pk_bf16_f32 v155, v130, v131
  buffer_store_dwordx4 v[152:155], v1, s[8:11], s64 offen sc1
  s_add_u32 s64, s64, 147456
  s_nop 1
  s_waitcnt vmcnt(0)
  s_barrier
  s_cmp_eq_u32 s23, 0
  s_cbranch_scc0 L_k3_nopub
  s_lshl_b32 s64, s51, 10
  v_mov_b32 v12, s64
  v_mov_b32 v13, 1
  s_mov_b64 exec, 1
  buffer_atomic_add v13, v12, s[36:39], 0 offen
  s_mov_b64 exec, -1
L_k3_nopub:
  s_waitcnt vmcnt(0)
  s_endpgm

L_code_end:
.section .rodata,"a"
.p2align 6
.amdhsa_kernel k2_gemm1_kernel
  .amdhsa_next_free_vgpr 510
  .amdhsa_next_free_sgpr 102
  .amdhsa_accum_offset 256
  .amdhsa_group_segment_fixed_size 0
  .amdhsa_kernarg_size 88
  .amdhsa_user_sgpr_count 2
  .amdhsa_user_sgpr_kernarg_segment_ptr 1
  .amdhsa_system_sgpr_workgroup_id_x 1
  .amdhsa_float_denorm_mode_32 3
  .amdhsa_float_denorm_mode_16_64 3
.end_amdhsa_kernel

.p2align 6
.amdhsa_kernel k3_gemm2_kernel
  .amdhsa_next_free_vgpr 256
  .amdhsa_next_free_sgpr 102
  .amdhsa_accum_offset 160
  .amdhsa_group_segment_fixed_size 0
  .amdhsa_kernarg_size 88
  .amdhsa_user_sgpr_count 2
  .amdhsa_user_sgpr_kernarg_segment_ptr 1
  .amdhsa_system_sgpr_workgroup_id_x 1
  .amdhsa_float_denorm_mode_32 3
  .amdhsa_float_denorm_mode_16_64 3
.end_amdhsa_kernel
```
